```python
import torch

def _softmax(x, axis=-1):
    return torch.softmax(x, dim=axis)
def _gelu(x):
    return torch.nn.functional.gelu(x, approximate="tanh")
def _silu(x):
    return torch.nn.functional.silu(x)
def _sigmoid(x):
    return torch.sigmoid(x)
def _layernorm(x, axis=-1, eps=1e-5):
    m = x.mean(dim=axis, keepdim=True)
    v = x.var(dim=axis, keepdim=True, unbiased=False)
    return (x - m) / torch.sqrt(v + eps)
def _scatter_add(tgt, idx, src, axis=0):
    return tgt.clone().index_add_(axis, idx, src)
def _segment_sum(src, seg, n):
    out = torch.zeros((n,) + src.shape[1:], dtype=src.dtype)
    return out.index_add_(0, seg, src)
def _pad(x, pw):
    flat = tuple(v for pair in reversed(pw) for v in pair)
    return torch.nn.functional.pad(x, flat)

kernel_name = 'standalone__gqa_block_cached__near_ridge'

def setup_inputs():

    _w = (lambda a: (lambda t: t.to(torch.bfloat16) if t.is_floating_point() else t)(torch.as_tensor(a)))
    B, Sq, D = 8, 48, 1024
    Hq, Hkv, Sk, Dh = 32, 4, 2048, 128
    assert Hq % Hkv == 0, (Hq, Hkv)
    return {
        "x": _w((lambda *s: torch.randn(*s, dtype=torch.bfloat16) * 0.8)(B, Sq, D)),
        "k_cache": _w((lambda *s: torch.randn(*s, dtype=torch.bfloat16) * 0.8)(B, Hkv, Sk, Dh)),
        "v_cache": _w((lambda *s: torch.randn(*s, dtype=torch.bfloat16) * 0.05)(B, Hkv, Sk, Dh)),
        "wq": _w((lambda *s: torch.randn(*s, dtype=torch.bfloat16) * 0.8)(D, Hq * Dh) * (D ** -0.5)),
        "wo": _w((lambda *s: torch.randn(*s, dtype=torch.bfloat16) * 0.05)(Hq * Dh, D) * ((Hq * Dh) ** -0.5)),
    }

def reference(x, k_cache, v_cache, wq, wo):
    B, Sq, D = x.shape
    Hq, Dh = 32, 128
    Hkv = k_cache.shape[1]
    rep = Hq // Hkv
    q = (lambda x, *d: x.permute(*d))((x @ wq).reshape(B, Sq, Hq, Dh), 0, 2, 1, 3)
    k = (lambda x, n, axis: torch.repeat_interleave(x, n, dim=axis))(k_cache, rep, axis=1)
    v = (lambda x, n, axis: torch.repeat_interleave(x, n, dim=axis))(v_cache, rep, axis=1)
    scores = torch.einsum("bhqd,bhkd->bhqk", q, k) * (Dh ** -0.5)
    p = _softmax(scores, axis=-1)
    o = torch.einsum("bhqk,bhkd->bhqd", p, v)
    return (lambda x, *d: x.permute(*d))(o, 0, 2, 1, 3).reshape(B, Sq, Hq * Dh) @ wo
```

```asm
; @launch kernel=gqa_attn_kernel grid=(256,1,1) block=(512,1,1) lds=163840
; @launch kernel=gqa_oproj_kernel grid=(256,1,1) block=(512,1,1) lds=49152
.amdgcn_target "amdgcn-amd-amdhsa--gfx950"
.text
.globl gqa_attn_kernel
.p2align 8
.type gqa_attn_kernel,@function
gqa_attn_kernel:
    s_cmp_ge_u32 s2, 256
    s_cbranch_scc1 K1_END
    s_load_dwordx4 s[24:27], s[0:1], 0
    s_load_dwordx4 s[28:31], s[0:1], 16
    s_load_dwordx2 s[32:33], s[0:1], 56
    s_load_dwordx2 s[56:57], s[0:1], 32
    v_lshrrev_b32 v1, 6, v0
    v_and_b32 v2, 63, v0
    v_readfirstlane_b32 s34, v1
    s_and_b32 s35, s2, 7
    s_lshr_b32 s36, s2, 3
    s_lshr_b32 s37, s35, 1
    s_and_b32 s38, s35, 1
    s_lshl_b32 s38, s38, 2
    s_lshr_b32 s39, s36, 3
    s_add_u32 s38, s38, s39
    s_and_b32 s39, s36, 7
    s_lshl_b32 s40, s37, 3
    s_add_u32 s39, s39, s40
    v_lshrrev_b32 v72, 4, v2
    v_and_b32 v73, 15, v2
    s_and_b32 s40, s34, 1
    s_mul_i32 s42, s34, 20480
    s_lshl_b32 s41, s40, 3
    v_lshlrev_b32 v3, 1, v72
    v_xor_b32 v3, v3, v73
    v_xor_b32 v4, s41, v3
    v_lshlrev_b32 v4, 4, v4
    v_lshl_add_u32 v4, v72, 13, v4
    s_lshl_b32 s41, s34, 16
    v_add_u32 v64, s41, v4
    s_lshl_b32 s41, s34, 3
    v_lshrrev_b32 v5, 3, v2
    v_add_u32 v7, s41, v5
    v_bfe_u32 v8, v7, 1, 3
    v_and_b32 v9, 7, v2
    v_xor_b32 v8, v8, v9
    v_lshlrev_b32 v8, 4, v8
    v_lshl_add_u32 v65, v7, 11, v8
    s_waitcnt lgkmcnt(0)
    s_mul_i32 s45, s38, 98304
    s_add_u32 s4, s24, s45
    s_addc_u32 s5, s25, 0
    s_mov_b32 s6, 98304
    s_mov_b32 s7, 0x20000
    s_lshl_b32 s45, s39, 8
    s_add_u32 s8, s30, s45
    s_addc_u32 s9, s31, 0
    s_sub_u32 s10, 0x800000, s45
    s_mov_b32 s11, 0x20000
    s_mov_b32 s47, 0
    s_mov_b32 s48, 32768
    s_mov_b32 s49, 0
    s_add_u32 m0, s42, 6144
    s_nop 0
    buffer_load_dwordx4 v64, s[8:11], s47 offen lds
    s_add_u32 m0, s42, 7168
    s_nop 0
    buffer_load_dwordx4 v64, s[8:11], s48 offen lds
    s_add_u32 m0, s42, 8192
    s_nop 0
    buffer_load_dwordx4 v65, s[4:7], s49 offen lds
    s_mov_b32 s47, 524288
    s_mov_b32 s48, 557056
    s_mov_b32 s49, 128
    s_add_u32 m0, s42, 9216
    s_nop 0
    buffer_load_dwordx4 v64, s[8:11], s47 offen lds
    s_add_u32 m0, s42, 10240
    s_nop 0
    buffer_load_dwordx4 v64, s[8:11], s48 offen lds
    s_add_u32 m0, s42, 11264
    s_nop 0
    buffer_load_dwordx4 v65, s[4:7], s49 offen lds
    s_mov_b32 s47, 1048576
    s_mov_b32 s48, 1081344
    s_mov_b32 s49, 256
    s_add_u32 m0, s42, 12288
    s_nop 0
    buffer_load_dwordx4 v64, s[8:11], s47 offen lds
    s_add_u32 m0, s42, 13312
    s_nop 0
    buffer_load_dwordx4 v64, s[8:11], s48 offen lds
    s_add_u32 m0, s42, 14336
    s_nop 0
    buffer_load_dwordx4 v65, s[4:7], s49 offen lds
    s_mov_b32 s47, 1572864
    s_mov_b32 s48, 1605632
    s_mov_b32 s49, 384
    s_add_u32 m0, s42, 15360
    s_nop 0
    buffer_load_dwordx4 v64, s[8:11], s47 offen lds
    s_add_u32 m0, s42, 16384
    s_nop 0
    buffer_load_dwordx4 v64, s[8:11], s48 offen lds
    s_add_u32 m0, s42, 17408
    s_nop 0
    buffer_load_dwordx4 v65, s[4:7], s49 offen lds
    s_mov_b32 s47, 2097152
    s_mov_b32 s48, 2129920
    s_mov_b32 s49, 512
    s_add_u32 m0, s42, 0
    s_nop 0
    buffer_load_dwordx4 v64, s[8:11], s47 offen lds
    s_add_u32 m0, s42, 1024
    s_nop 0
    buffer_load_dwordx4 v64, s[8:11], s48 offen lds
    s_add_u32 m0, s42, 2048
    s_nop 0
    buffer_load_dwordx4 v65, s[4:7], s49 offen lds
    s_lshl_b32 s45, s38, 2
    s_add_u32 s45, s45, s37
    s_lshl_b32 s45, s45, 19
    s_lshl_b32 s46, s34, 16
    s_add_u32 s45, s45, s46
    s_add_u32 s12, s26, s45
    s_addc_u32 s13, s27, 0
    s_mov_b32 s14, 65536
    s_mov_b32 s15, 0x20000
    s_add_u32 s16, s28, s45
    s_addc_u32 s17, s29, 0
    s_mov_b32 s18, 65536
    s_mov_b32 s19, 0x20000
    s_lshl_b32 s45, s38, 5
    s_add_u32 s45, s45, s39
    s_mul_i32 s45, s45, 12288
    s_add_u32 s20, s32, s45
    s_addc_u32 s21, s33, 0
    s_mov_b32 s22, 12288
    s_mov_b32 s23, 0x20000
    s_and_b32 s58, s35, 1
    s_lshl_b32 s58, s58, 5
    s_add_u32 s58, s58, s36
    s_lshl_b32 s58, s58, 1
    s_lshr_b32 s45, s34, 2
    s_add_u32 s58, s58, s45
    s_lshl_b32 s59, s37, 2
    s_and_b32 s45, s34, 3
    s_add_u32 s59, s59, s45
    s_lshl_b32 s45, s58, 16
    s_lshl_b32 s46, s59, 7
    s_add_u32 s45, s45, s46
    s_add_u32 s24, s56, s45
    s_addc_u32 s25, s57, 0
    s_sub_u32 s26, 65536, s46
    s_mov_b32 s27, 0x20000
    s_lshl_b32 s45, s59, 8
    s_add_u32 s45, s45, s58
    s_lshl_b32 s45, s45, 11
    s_add_u32 s45, s45, 4194304
    s_add_u32 s28, s32, s45
    s_addc_u32 s29, s33, 0
    s_mov_b32 s30, 264192
    s_mov_b32 s31, 0x20000
    v_lshlrev_b32 v4, 4, v3
    v_lshl_add_u32 v236, v72, 8, v4
    v_xor_b32 v237, 128, v236
    v_xor_b32 v238, 16, v236
    v_xor_b32 v239, 144, v236
    v_lshlrev_b32 v4, 1, v72
    v_xor_b32 v4, v4, v9
    v_lshlrev_b32 v4, 4, v4
    v_lshl_add_u32 v255, v5, 11, v4
    v_lshrrev_b32 v10, 2, v73
    v_and_b32 v11, 3, v73
    v_and_b32 v12, 1, v72
    v_lshl_add_u32 v12, v12, 2, v10
    v_xor_b32 v4, s34, v12
    v_lshlrev_b32 v4, 5, v4
    v_lshl_add_u32 v4, v10, 8, v4
    v_lshl_add_u32 v4, v11, 3, v4
    v_mul_u32_u24 v6, 20480, v72
    v_add_u32 v66, v4, v6
    v_add_u32 v67, 81920, v66
    v_lshrrev_b32 v4, 1, v73
    v_xor_b32 v4, v4, v72
    v_lshlrev_b32 v4, 4, v4
    v_and_b32 v6, 7, v73
    v_lshl_add_u32 v4, v6, 7, v4
    v_lshrrev_b32 v7, 3, v73
    v_mul_u32_u24 v8, 20480, v7
    v_add_u32 v68, v4, v8
    v_xor_b32 v69, 64, v68
    v_add_u32 v70, 81920, v68
    v_add_u32 v71, 81920, v69
    v_lshl_add_u32 v4, v6, 1, v7
    v_lshlrev_b32 v8, 2, v72
    v_xor_b32 v4, v4, v8
    v_lshlrev_b32 v4, 4, v4
    v_lshl_add_u32 v4, v73, 8, v4
    v_add_u32 v240, s42, v4
    v_xor_b32 v241, 16, v240
    v_xor_b32 v242, 32, v240
    v_xor_b32 v243, 48, v240
    v_lshrrev_b32 v4, 1, v72
    v_lshl_add_u32 v4, v12, 1, v4
    v_lshrrev_b32 v6, 1, v11
    v_xor_b32 v4, v4, v6
    v_lshlrev_b32 v4, 4, v4
    v_and_b32 v6, 1, v11
    v_lshl_add_u32 v4, v6, 3, v4
    v_add_u32 v8, v8, v10
    v_lshl_add_u32 v4, v8, 8, v4
    v_add_u32 v244, s42, v4
    v_xor_b32 v245, 32, v244
    v_xor_b32 v246, 64, v244
    v_xor_b32 v247, 96, v244
    v_xor_b32 v248, 128, v244
    v_xor_b32 v249, 160, v244
    v_xor_b32 v250, 192, v244
    v_xor_b32 v251, 224, v244
    v_lshrrev_b32 v4, 1, v72
    v_mul_u32_u24 v4, 768, v4
    v_lshl_add_u32 v4, v73, 4, v4
    v_and_b32 v6, 1, v72
    v_lshl_add_u32 v4, v6, 3, v4
    v_add_u32 v74, s42, v4
    v_mul_u32_u24 v4, 40960, v72
    v_lshl_add_u32 v75, v73, 4, v4
    v_mov_b32 v168, 0x3f803f80
    v_mov_b32 v169, 0x3f803f80
    v_mov_b32 v170, 0x3f803f80
    v_mov_b32 v171, 0x3f803f80
    s_mov_b32 s52, 0x3e0293ee
    s_mov_b32 s53, 0x41800000
    v_mov_b32 v32, 0
    v_mov_b32 v33, 0
    v_mov_b32 v34, 0
    v_mov_b32 v35, 0
    v_mov_b32 v36, 0
    v_mov_b32 v37, 0
    v_mov_b32 v38, 0
    v_mov_b32 v39, 0
    v_mov_b32 v40, 0
    v_mov_b32 v41, 0
    v_mov_b32 v42, 0
    v_mov_b32 v43, 0
    v_mov_b32 v44, 0
    v_mov_b32 v45, 0
    v_mov_b32 v46, 0
    v_mov_b32 v47, 0
    v_mov_b32 v48, 0
    v_mov_b32 v49, 0
    v_mov_b32 v50, 0
    v_mov_b32 v51, 0
    v_mov_b32 v52, 0
    v_mov_b32 v53, 0
    v_mov_b32 v54, 0
    v_mov_b32 v55, 0
    v_mov_b32 v56, 0
    v_mov_b32 v57, 0
    v_mov_b32 v58, 0
    v_mov_b32 v59, 0
    v_mov_b32 v60, 0
    v_mov_b32 v61, 0
    v_mov_b32 v62, 0
    v_mov_b32 v63, 0
    v_mov_b32 v76, 0
    v_mov_b32 v77, 0
    v_mov_b32 v78, 0
    v_mov_b32 v79, 0
    v_mov_b32 v80, 0
    v_mov_b32 v81, 0
    v_mov_b32 v82, 0
    v_mov_b32 v83, 0
    v_mov_b32 v84, 0
    v_mov_b32 v85, 0
    v_mov_b32 v86, 0
    v_mov_b32 v87, 0
    v_mov_b32 v88, 0
    v_mov_b32 v89, 0
    v_mov_b32 v90, 0
    v_mov_b32 v91, 0
    v_mov_b32 v92, 0
    v_mov_b32 v93, 0
    v_mov_b32 v94, 0
    v_mov_b32 v95, 0
    v_mov_b32 v96, 0
    v_mov_b32 v97, 0
    v_mov_b32 v98, 0
    v_mov_b32 v99, 0
    v_mov_b32 v100, 0
    v_mov_b32 v101, 0
    v_mov_b32 v102, 0
    v_mov_b32 v103, 0
    v_mov_b32 v104, 0
    v_mov_b32 v105, 0
    v_mov_b32 v106, 0
    v_mov_b32 v107, 0
    s_mul_i32 s60, s36, 0
    s_lshl_b32 s60, s60, 13
    s_waitcnt vmcnt(12)
    s_barrier
    ds_read_b64_tr_b16 v[0:1], v66 offset:6144
    ds_read_b64_tr_b16 v[2:3], v66 offset:7168
    ds_read_b128 v[4:7], v68 offset:8192
    ds_read_b128 v[8:11], v68 offset:49152
    ds_read_b128 v[12:15], v70 offset:8192
    ds_read_b64_tr_b16 v[16:17], v67 offset:6144
    ds_read_b64_tr_b16 v[18:19], v67 offset:7168
    ds_read_b128 v[20:23], v69 offset:8192
    ds_read_b128 v[24:27], v69 offset:49152
    ds_read_b128 v[28:31], v71 offset:8192
    s_mov_b32 s47, 2621440
    s_mov_b32 s48, 2654208
    s_mov_b32 s49, 640
    s_add_u32 m0, s42, 3072
    s_nop 0
    buffer_load_dwordx4 v64, s[8:11], s47 offen lds
    s_add_u32 m0, s42, 4096
    s_nop 0
    buffer_load_dwordx4 v64, s[8:11], s48 offen lds
    s_add_u32 m0, s42, 5120
    s_nop 0
    buffer_load_dwordx4 v65, s[4:7], s49 offen lds
    s_waitcnt lgkmcnt(7)
    v_mfma_f32_16x16x32_bf16 v[172:175], v[0:3], v[4:7], 0
    s_waitcnt lgkmcnt(6)
    v_mfma_f32_16x16x32_bf16 v[176:179], v[0:3], v[8:11], 0
    s_waitcnt lgkmcnt(5)
    v_mfma_f32_16x16x32_bf16 v[180:183], v[0:3], v[12:15], 0
    s_waitcnt lgkmcnt(2)
    v_mfma_f32_16x16x32_bf16 v[172:175], v[16:19], v[20:23], v[172:175]
    s_waitcnt lgkmcnt(1)
    v_mfma_f32_16x16x32_bf16 v[176:179], v[16:19], v[24:27], v[176:179]
    s_waitcnt lgkmcnt(0)
    v_mfma_f32_16x16x32_bf16 v[180:183], v[16:19], v[28:31], v[180:183]
    s_waitcnt vmcnt(12)
    s_barrier
    ds_read_b64_tr_b16 v[0:1], v66 offset:9216
    ds_read_b64_tr_b16 v[2:3], v66 offset:10240
    ds_read_b128 v[4:7], v68 offset:11264
    ds_read_b128 v[8:11], v68 offset:52224
    ds_read_b128 v[12:15], v70 offset:11264
    ds_read_b64_tr_b16 v[16:17], v67 offset:9216
    ds_read_b64_tr_b16 v[18:19], v67 offset:10240
    ds_read_b128 v[20:23], v69 offset:11264
    ds_read_b128 v[24:27], v69 offset:52224
    ds_read_b128 v[28:31], v71 offset:11264
    s_mov_b32 s47, 3145728
    s_mov_b32 s48, 3178496
    s_mov_b32 s49, 768
    s_add_u32 m0, s42, 6144
    s_nop 0
    buffer_load_dwordx4 v64, s[8:11], s47 offen lds
    s_add_u32 m0, s42, 7168
    s_nop 0
    buffer_load_dwordx4 v64, s[8:11], s48 offen lds
    s_add_u32 m0, s42, 8192
    s_nop 0
    buffer_load_dwordx4 v65, s[4:7], s49 offen lds
    s_waitcnt lgkmcnt(7)
    v_mfma_f32_16x16x32_bf16 v[172:175], v[0:3], v[4:7], v[172:175]
    s_waitcnt lgkmcnt(6)
    v_mfma_f32_16x16x32_bf16 v[176:179], v[0:3], v[8:11], v[176:179]
    s_waitcnt lgkmcnt(5)
    v_mfma_f32_16x16x32_bf16 v[180:183], v[0:3], v[12:15], v[180:183]
    s_waitcnt lgkmcnt(2)
    v_mfma_f32_16x16x32_bf16 v[172:175], v[16:19], v[20:23], v[172:175]
    s_waitcnt lgkmcnt(1)
    v_mfma_f32_16x16x32_bf16 v[176:179], v[16:19], v[24:27], v[176:179]
    s_waitcnt lgkmcnt(0)
    v_mfma_f32_16x16x32_bf16 v[180:183], v[16:19], v[28:31], v[180:183]
    s_waitcnt vmcnt(12)
    s_barrier
    ds_read_b64_tr_b16 v[0:1], v66 offset:12288
    ds_read_b64_tr_b16 v[2:3], v66 offset:13312
    ds_read_b128 v[4:7], v68 offset:14336
    ds_read_b128 v[8:11], v68 offset:55296
    ds_read_b128 v[12:15], v70 offset:14336
    ds_read_b64_tr_b16 v[16:17], v67 offset:12288
    ds_read_b64_tr_b16 v[18:19], v67 offset:13312
    ds_read_b128 v[20:23], v69 offset:14336
    ds_read_b128 v[24:27], v69 offset:55296
    ds_read_b128 v[28:31], v71 offset:14336
    s_mov_b32 s47, 3670016
    s_mov_b32 s48, 3702784
    s_mov_b32 s49, 896
    s_add_u32 m0, s42, 9216
    s_nop 0
    buffer_load_dwordx4 v64, s[8:11], s47 offen lds
    s_add_u32 m0, s42, 10240
    s_nop 0
    buffer_load_dwordx4 v64, s[8:11], s48 offen lds
    s_add_u32 m0, s42, 11264
    s_nop 0
    buffer_load_dwordx4 v65, s[4:7], s49 offen lds
    s_waitcnt lgkmcnt(7)
    v_mfma_f32_16x16x32_bf16 v[172:175], v[0:3], v[4:7], v[172:175]
    s_waitcnt lgkmcnt(6)
    v_mfma_f32_16x16x32_bf16 v[176:179], v[0:3], v[8:11], v[176:179]
    s_waitcnt lgkmcnt(5)
    v_mfma_f32_16x16x32_bf16 v[180:183], v[0:3], v[12:15], v[180:183]
    s_waitcnt lgkmcnt(2)
    v_mfma_f32_16x16x32_bf16 v[172:175], v[16:19], v[20:23], v[172:175]
    s_waitcnt lgkmcnt(1)
    v_mfma_f32_16x16x32_bf16 v[176:179], v[16:19], v[24:27], v[176:179]
    s_waitcnt lgkmcnt(0)
    v_mfma_f32_16x16x32_bf16 v[180:183], v[16:19], v[28:31], v[180:183]
    s_waitcnt vmcnt(12)
    s_barrier
    ds_read_b64_tr_b16 v[0:1], v66 offset:15360
    ds_read_b64_tr_b16 v[2:3], v66 offset:16384
    ds_read_b128 v[4:7], v68 offset:17408
    ds_read_b128 v[8:11], v68 offset:58368
    ds_read_b128 v[12:15], v70 offset:17408
    ds_read_b64_tr_b16 v[16:17], v67 offset:15360
    ds_read_b64_tr_b16 v[18:19], v67 offset:16384
    ds_read_b128 v[20:23], v69 offset:17408
    ds_read_b128 v[24:27], v69 offset:58368
    ds_read_b128 v[28:31], v71 offset:17408
    s_mov_b32 s47, 4194304
    s_mov_b32 s48, 4227072
    s_mov_b32 s49, 1024
    s_add_u32 m0, s42, 12288
    s_nop 0
    buffer_load_dwordx4 v64, s[8:11], s47 offen lds
    s_add_u32 m0, s42, 13312
    s_nop 0
    buffer_load_dwordx4 v64, s[8:11], s48 offen lds
    s_add_u32 m0, s42, 14336
    s_nop 0
    buffer_load_dwordx4 v65, s[4:7], s49 offen lds
    s_waitcnt lgkmcnt(7)
    v_mfma_f32_16x16x32_bf16 v[172:175], v[0:3], v[4:7], v[172:175]
    s_waitcnt lgkmcnt(6)
    v_mfma_f32_16x16x32_bf16 v[176:179], v[0:3], v[8:11], v[176:179]
    s_waitcnt lgkmcnt(5)
    v_mfma_f32_16x16x32_bf16 v[180:183], v[0:3], v[12:15], v[180:183]
    s_waitcnt lgkmcnt(2)
    v_mfma_f32_16x16x32_bf16 v[172:175], v[16:19], v[20:23], v[172:175]
    s_waitcnt lgkmcnt(1)
    v_mfma_f32_16x16x32_bf16 v[176:179], v[16:19], v[24:27], v[176:179]
    s_waitcnt lgkmcnt(0)
    v_mfma_f32_16x16x32_bf16 v[180:183], v[16:19], v[28:31], v[180:183]
    s_waitcnt vmcnt(12)
    s_barrier
    ds_read_b64_tr_b16 v[0:1], v66 offset:0
    ds_read_b64_tr_b16 v[2:3], v66 offset:1024
    ds_read_b128 v[4:7], v68 offset:2048
    ds_read_b128 v[8:11], v68 offset:43008
    ds_read_b128 v[12:15], v70 offset:2048
    ds_read_b64_tr_b16 v[16:17], v67 offset:0
    ds_read_b64_tr_b16 v[18:19], v67 offset:1024
    ds_read_b128 v[20:23], v69 offset:2048
    ds_read_b128 v[24:27], v69 offset:43008
    ds_read_b128 v[28:31], v71 offset:2048
    s_mov_b32 s47, 4718592
    s_mov_b32 s48, 4751360
    s_mov_b32 s49, 1152
    s_add_u32 m0, s42, 15360
    s_nop 0
    buffer_load_dwordx4 v64, s[8:11], s47 offen lds
    s_add_u32 m0, s42, 16384
    s_nop 0
    buffer_load_dwordx4 v64, s[8:11], s48 offen lds
    s_add_u32 m0, s42, 17408
    s_nop 0
    buffer_load_dwordx4 v65, s[4:7], s49 offen lds
    s_waitcnt lgkmcnt(7)
    v_mfma_f32_16x16x32_bf16 v[172:175], v[0:3], v[4:7], v[172:175]
    s_waitcnt lgkmcnt(6)
    v_mfma_f32_16x16x32_bf16 v[176:179], v[0:3], v[8:11], v[176:179]
    s_waitcnt lgkmcnt(5)
    v_mfma_f32_16x16x32_bf16 v[180:183], v[0:3], v[12:15], v[180:183]
    s_waitcnt lgkmcnt(2)
    v_mfma_f32_16x16x32_bf16 v[172:175], v[16:19], v[20:23], v[172:175]
    s_waitcnt lgkmcnt(1)
    v_mfma_f32_16x16x32_bf16 v[176:179], v[16:19], v[24:27], v[176:179]
    s_waitcnt lgkmcnt(0)
    v_mfma_f32_16x16x32_bf16 v[180:183], v[16:19], v[28:31], v[180:183]
    s_waitcnt vmcnt(12)
    s_barrier
    ds_read_b64_tr_b16 v[0:1], v66 offset:3072
    ds_read_b64_tr_b16 v[2:3], v66 offset:4096
    ds_read_b128 v[4:7], v68 offset:5120
    ds_read_b128 v[8:11], v68 offset:46080
    ds_read_b128 v[12:15], v70 offset:5120
    ds_read_b64_tr_b16 v[16:17], v67 offset:3072
    ds_read_b64_tr_b16 v[18:19], v67 offset:4096
    ds_read_b128 v[20:23], v69 offset:5120
    ds_read_b128 v[24:27], v69 offset:46080
    ds_read_b128 v[28:31], v71 offset:5120
    s_mov_b32 s47, 5242880
    s_mov_b32 s48, 5275648
    s_mov_b32 s49, 1280
    s_add_u32 m0, s42, 0
    s_nop 0
    buffer_load_dwordx4 v64, s[8:11], s47 offen lds
    s_add_u32 m0, s42, 1024
    s_nop 0
    buffer_load_dwordx4 v64, s[8:11], s48 offen lds
    s_add_u32 m0, s42, 2048
    s_nop 0
    buffer_load_dwordx4 v65, s[4:7], s49 offen lds
    s_waitcnt lgkmcnt(7)
    v_mfma_f32_16x16x32_bf16 v[172:175], v[0:3], v[4:7], v[172:175]
    s_waitcnt lgkmcnt(6)
    v_mfma_f32_16x16x32_bf16 v[176:179], v[0:3], v[8:11], v[176:179]
    s_waitcnt lgkmcnt(5)
    v_mfma_f32_16x16x32_bf16 v[180:183], v[0:3], v[12:15], v[180:183]
    s_waitcnt lgkmcnt(2)
    v_mfma_f32_16x16x32_bf16 v[172:175], v[16:19], v[20:23], v[172:175]
    s_waitcnt lgkmcnt(1)
    v_mfma_f32_16x16x32_bf16 v[176:179], v[16:19], v[24:27], v[176:179]
    s_waitcnt lgkmcnt(0)
    v_mfma_f32_16x16x32_bf16 v[180:183], v[16:19], v[28:31], v[180:183]
    s_waitcnt vmcnt(12)
    s_barrier
    ds_read_b64_tr_b16 v[0:1], v66 offset:6144
    ds_read_b64_tr_b16 v[2:3], v66 offset:7168
    ds_read_b128 v[4:7], v68 offset:8192
    ds_read_b128 v[8:11], v68 offset:49152
    ds_read_b128 v[12:15], v70 offset:8192
    ds_read_b64_tr_b16 v[16:17], v67 offset:6144
    ds_read_b64_tr_b16 v[18:19], v67 offset:7168
    ds_read_b128 v[20:23], v69 offset:8192
    ds_read_b128 v[24:27], v69 offset:49152
    ds_read_b128 v[28:31], v71 offset:8192
    s_mov_b32 s47, 5767168
    s_mov_b32 s48, 5799936
    s_mov_b32 s49, 1408
    s_add_u32 m0, s42, 3072
    s_nop 0
    buffer_load_dwordx4 v64, s[8:11], s47 offen lds
    s_add_u32 m0, s42, 4096
    s_nop 0
    buffer_load_dwordx4 v64, s[8:11], s48 offen lds
    s_add_u32 m0, s42, 5120
    s_nop 0
    buffer_load_dwordx4 v65, s[4:7], s49 offen lds
    s_waitcnt lgkmcnt(7)
    v_mfma_f32_16x16x32_bf16 v[172:175], v[0:3], v[4:7], v[172:175]
    s_waitcnt lgkmcnt(6)
    v_mfma_f32_16x16x32_bf16 v[176:179], v[0:3], v[8:11], v[176:179]
    s_waitcnt lgkmcnt(5)
    v_mfma_f32_16x16x32_bf16 v[180:183], v[0:3], v[12:15], v[180:183]
    s_waitcnt lgkmcnt(2)
    v_mfma_f32_16x16x32_bf16 v[172:175], v[16:19], v[20:23], v[172:175]
    s_waitcnt lgkmcnt(1)
    v_mfma_f32_16x16x32_bf16 v[176:179], v[16:19], v[24:27], v[176:179]
    s_waitcnt lgkmcnt(0)
    v_mfma_f32_16x16x32_bf16 v[180:183], v[16:19], v[28:31], v[180:183]
    s_waitcnt vmcnt(12)
    s_barrier
    ds_read_b64_tr_b16 v[0:1], v66 offset:9216
    ds_read_b64_tr_b16 v[2:3], v66 offset:10240
    ds_read_b128 v[4:7], v68 offset:11264
    ds_read_b128 v[8:11], v68 offset:52224
    ds_read_b128 v[12:15], v70 offset:11264
    ds_read_b64_tr_b16 v[16:17], v67 offset:9216
    ds_read_b64_tr_b16 v[18:19], v67 offset:10240
    ds_read_b128 v[20:23], v69 offset:11264
    ds_read_b128 v[24:27], v69 offset:52224
    ds_read_b128 v[28:31], v71 offset:11264
    s_mov_b32 s47, 6291456
    s_mov_b32 s48, 6324224
    s_mov_b32 s49, 1536
    s_add_u32 m0, s42, 6144
    s_nop 0
    buffer_load_dwordx4 v64, s[8:11], s47 offen lds
    s_add_u32 m0, s42, 7168
    s_nop 0
    buffer_load_dwordx4 v64, s[8:11], s48 offen lds
    s_add_u32 m0, s42, 8192
    s_nop 0
    buffer_load_dwordx4 v65, s[4:7], s49 offen lds
    s_waitcnt lgkmcnt(7)
    v_mfma_f32_16x16x32_bf16 v[172:175], v[0:3], v[4:7], v[172:175]
    s_waitcnt lgkmcnt(6)
    v_mfma_f32_16x16x32_bf16 v[176:179], v[0:3], v[8:11], v[176:179]
    s_waitcnt lgkmcnt(5)
    v_mfma_f32_16x16x32_bf16 v[180:183], v[0:3], v[12:15], v[180:183]
    s_waitcnt lgkmcnt(2)
    v_mfma_f32_16x16x32_bf16 v[172:175], v[16:19], v[20:23], v[172:175]
    s_waitcnt lgkmcnt(1)
    v_mfma_f32_16x16x32_bf16 v[176:179], v[16:19], v[24:27], v[176:179]
    s_waitcnt lgkmcnt(0)
    v_mfma_f32_16x16x32_bf16 v[180:183], v[16:19], v[28:31], v[180:183]
    s_waitcnt vmcnt(12)
    s_barrier
    ds_read_b64_tr_b16 v[0:1], v66 offset:12288
    ds_read_b64_tr_b16 v[2:3], v66 offset:13312
    ds_read_b128 v[4:7], v68 offset:14336
    ds_read_b128 v[8:11], v68 offset:55296
    ds_read_b128 v[12:15], v70 offset:14336
    ds_read_b64_tr_b16 v[16:17], v67 offset:12288
    ds_read_b64_tr_b16 v[18:19], v67 offset:13312
    ds_read_b128 v[20:23], v69 offset:14336
    ds_read_b128 v[24:27], v69 offset:55296
    ds_read_b128 v[28:31], v71 offset:14336
    s_mov_b32 s47, 6815744
    s_mov_b32 s48, 6848512
    s_mov_b32 s49, 1664
    s_add_u32 m0, s42, 9216
    s_nop 0
    buffer_load_dwordx4 v64, s[8:11], s47 offen lds
    s_add_u32 m0, s42, 10240
    s_nop 0
    buffer_load_dwordx4 v64, s[8:11], s48 offen lds
    s_add_u32 m0, s42, 11264
    s_nop 0
    buffer_load_dwordx4 v65, s[4:7], s49 offen lds
    s_waitcnt lgkmcnt(7)
    v_mfma_f32_16x16x32_bf16 v[172:175], v[0:3], v[4:7], v[172:175]
    s_waitcnt lgkmcnt(6)
    v_mfma_f32_16x16x32_bf16 v[176:179], v[0:3], v[8:11], v[176:179]
    s_waitcnt lgkmcnt(5)
    v_mfma_f32_16x16x32_bf16 v[180:183], v[0:3], v[12:15], v[180:183]
    s_waitcnt lgkmcnt(2)
    v_mfma_f32_16x16x32_bf16 v[172:175], v[16:19], v[20:23], v[172:175]
    s_waitcnt lgkmcnt(1)
    v_mfma_f32_16x16x32_bf16 v[176:179], v[16:19], v[24:27], v[176:179]
    s_waitcnt lgkmcnt(0)
    v_mfma_f32_16x16x32_bf16 v[180:183], v[16:19], v[28:31], v[180:183]
    s_waitcnt vmcnt(12)
    s_barrier
    ds_read_b64_tr_b16 v[0:1], v66 offset:15360
    ds_read_b64_tr_b16 v[2:3], v66 offset:16384
    ds_read_b128 v[4:7], v68 offset:17408
    ds_read_b128 v[8:11], v68 offset:58368
    ds_read_b128 v[12:15], v70 offset:17408
    ds_read_b64_tr_b16 v[16:17], v67 offset:15360
    ds_read_b64_tr_b16 v[18:19], v67 offset:16384
    ds_read_b128 v[20:23], v69 offset:17408
    ds_read_b128 v[24:27], v69 offset:58368
    ds_read_b128 v[28:31], v71 offset:17408
    s_mov_b32 s47, 7340032
    s_mov_b32 s48, 7372800
    s_mov_b32 s49, 1792
    s_add_u32 m0, s42, 12288
    s_nop 0
    buffer_load_dwordx4 v64, s[8:11], s47 offen lds
    s_add_u32 m0, s42, 13312
    s_nop 0
    buffer_load_dwordx4 v64, s[8:11], s48 offen lds
    s_add_u32 m0, s42, 14336
    s_nop 0
    buffer_load_dwordx4 v65, s[4:7], s49 offen lds
    s_waitcnt lgkmcnt(7)
    v_mfma_f32_16x16x32_bf16 v[172:175], v[0:3], v[4:7], v[172:175]
    s_waitcnt lgkmcnt(6)
    v_mfma_f32_16x16x32_bf16 v[176:179], v[0:3], v[8:11], v[176:179]
    s_waitcnt lgkmcnt(5)
    v_mfma_f32_16x16x32_bf16 v[180:183], v[0:3], v[12:15], v[180:183]
    s_waitcnt lgkmcnt(2)
    v_mfma_f32_16x16x32_bf16 v[172:175], v[16:19], v[20:23], v[172:175]
    s_waitcnt lgkmcnt(1)
    v_mfma_f32_16x16x32_bf16 v[176:179], v[16:19], v[24:27], v[176:179]
    s_waitcnt lgkmcnt(0)
    v_mfma_f32_16x16x32_bf16 v[180:183], v[16:19], v[28:31], v[180:183]
    s_waitcnt vmcnt(12)
    s_barrier
    ds_read_b64_tr_b16 v[0:1], v66 offset:0
    ds_read_b64_tr_b16 v[2:3], v66 offset:1024
    ds_read_b128 v[4:7], v68 offset:2048
    ds_read_b128 v[8:11], v68 offset:43008
    ds_read_b128 v[12:15], v70 offset:2048
    ds_read_b64_tr_b16 v[16:17], v67 offset:0
    ds_read_b64_tr_b16 v[18:19], v67 offset:1024
    ds_read_b128 v[20:23], v69 offset:2048
    ds_read_b128 v[24:27], v69 offset:43008
    ds_read_b128 v[28:31], v71 offset:2048
    s_mov_b32 s47, 7864320
    s_mov_b32 s48, 7897088
    s_mov_b32 s49, 1920
    s_add_u32 m0, s42, 15360
    s_nop 0
    buffer_load_dwordx4 v64, s[8:11], s47 offen lds
    s_add_u32 m0, s42, 16384
    s_nop 0
    buffer_load_dwordx4 v64, s[8:11], s48 offen lds
    s_add_u32 m0, s42, 17408
    s_nop 0
    buffer_load_dwordx4 v65, s[4:7], s49 offen lds
    s_waitcnt lgkmcnt(7)
    v_mfma_f32_16x16x32_bf16 v[172:175], v[0:3], v[4:7], v[172:175]
    s_waitcnt lgkmcnt(6)
    v_mfma_f32_16x16x32_bf16 v[176:179], v[0:3], v[8:11], v[176:179]
    s_waitcnt lgkmcnt(5)
    v_mfma_f32_16x16x32_bf16 v[180:183], v[0:3], v[12:15], v[180:183]
    s_waitcnt lgkmcnt(2)
    v_mfma_f32_16x16x32_bf16 v[172:175], v[16:19], v[20:23], v[172:175]
    s_waitcnt lgkmcnt(1)
    v_mfma_f32_16x16x32_bf16 v[176:179], v[16:19], v[24:27], v[176:179]
    s_waitcnt lgkmcnt(0)
    v_mfma_f32_16x16x32_bf16 v[180:183], v[16:19], v[28:31], v[180:183]
    s_waitcnt vmcnt(12)
    s_barrier
    ds_read_b64_tr_b16 v[0:1], v66 offset:3072
    ds_read_b64_tr_b16 v[2:3], v66 offset:4096
    ds_read_b128 v[4:7], v68 offset:5120
    ds_read_b128 v[8:11], v68 offset:46080
    ds_read_b128 v[12:15], v70 offset:5120
    ds_read_b64_tr_b16 v[16:17], v67 offset:3072
    ds_read_b64_tr_b16 v[18:19], v67 offset:4096
    ds_read_b128 v[20:23], v69 offset:5120
    ds_read_b128 v[24:27], v69 offset:46080
    ds_read_b128 v[28:31], v71 offset:5120
    s_waitcnt lgkmcnt(7)
    v_mfma_f32_16x16x32_bf16 v[172:175], v[0:3], v[4:7], v[172:175]
    s_waitcnt lgkmcnt(6)
    v_mfma_f32_16x16x32_bf16 v[176:179], v[0:3], v[8:11], v[176:179]
    s_waitcnt lgkmcnt(5)
    v_mfma_f32_16x16x32_bf16 v[180:183], v[0:3], v[12:15], v[180:183]
    s_waitcnt lgkmcnt(2)
    v_mfma_f32_16x16x32_bf16 v[172:175], v[16:19], v[20:23], v[172:175]
    s_waitcnt lgkmcnt(1)
    v_mfma_f32_16x16x32_bf16 v[176:179], v[16:19], v[24:27], v[176:179]
    s_waitcnt lgkmcnt(0)
    v_mfma_f32_16x16x32_bf16 v[180:183], v[16:19], v[28:31], v[180:183]
    s_waitcnt vmcnt(9)
    s_barrier
    ds_read_b64_tr_b16 v[0:1], v66 offset:6144
    ds_read_b64_tr_b16 v[2:3], v66 offset:7168
    ds_read_b128 v[4:7], v68 offset:8192
    ds_read_b128 v[8:11], v68 offset:49152
    ds_read_b128 v[12:15], v70 offset:8192
    ds_read_b64_tr_b16 v[16:17], v67 offset:6144
    ds_read_b64_tr_b16 v[18:19], v67 offset:7168
    ds_read_b128 v[20:23], v69 offset:8192
    ds_read_b128 v[24:27], v69 offset:49152
    ds_read_b128 v[28:31], v71 offset:8192
    s_add_u32 m0, s42, 0
    s_mov_b32 s51, 0
    buffer_load_dwordx4 v236, s[12:15], s51 offen offset:0 lds
    buffer_load_dwordx4 v237, s[12:15], s51 offen offset:1024 lds
    buffer_load_dwordx4 v238, s[12:15], s51 offen offset:2048 lds
    buffer_load_dwordx4 v239, s[12:15], s51 offen offset:3072 lds
    s_waitcnt lgkmcnt(7)
    v_mfma_f32_16x16x32_bf16 v[172:175], v[0:3], v[4:7], v[172:175]
    s_waitcnt lgkmcnt(6)
    v_mfma_f32_16x16x32_bf16 v[176:179], v[0:3], v[8:11], v[176:179]
    s_waitcnt lgkmcnt(5)
    v_mfma_f32_16x16x32_bf16 v[180:183], v[0:3], v[12:15], v[180:183]
    s_waitcnt lgkmcnt(2)
    v_mfma_f32_16x16x32_bf16 v[172:175], v[16:19], v[20:23], v[172:175]
    s_waitcnt lgkmcnt(1)
    v_mfma_f32_16x16x32_bf16 v[176:179], v[16:19], v[24:27], v[176:179]
    s_waitcnt lgkmcnt(0)
    v_mfma_f32_16x16x32_bf16 v[180:183], v[16:19], v[28:31], v[180:183]
    s_waitcnt vmcnt(10)
    s_barrier
    ds_read_b64_tr_b16 v[0:1], v66 offset:9216
    ds_read_b64_tr_b16 v[2:3], v66 offset:10240
    ds_read_b128 v[4:7], v68 offset:11264
    ds_read_b128 v[8:11], v68 offset:52224
    ds_read_b128 v[12:15], v70 offset:11264
    ds_read_b64_tr_b16 v[16:17], v67 offset:9216
    ds_read_b64_tr_b16 v[18:19], v67 offset:10240
    ds_read_b128 v[20:23], v69 offset:11264
    ds_read_b128 v[24:27], v69 offset:52224
    ds_read_b128 v[28:31], v71 offset:11264
    s_add_u32 m0, s42, 4096
    s_mov_b32 s51, 4096
    buffer_load_dwordx4 v236, s[12:15], s51 offen offset:0 lds
    buffer_load_dwordx4 v237, s[12:15], s51 offen offset:1024 lds
    buffer_load_dwordx4 v238, s[12:15], s51 offen offset:2048 lds
    buffer_load_dwordx4 v239, s[12:15], s51 offen offset:3072 lds
    s_waitcnt lgkmcnt(7)
    v_mfma_f32_16x16x32_bf16 v[172:175], v[0:3], v[4:7], v[172:175]
    s_waitcnt lgkmcnt(6)
    v_mfma_f32_16x16x32_bf16 v[176:179], v[0:3], v[8:11], v[176:179]
    s_waitcnt lgkmcnt(5)
    v_mfma_f32_16x16x32_bf16 v[180:183], v[0:3], v[12:15], v[180:183]
    s_waitcnt lgkmcnt(2)
    v_mfma_f32_16x16x32_bf16 v[172:175], v[16:19], v[20:23], v[172:175]
    s_waitcnt lgkmcnt(1)
    v_mfma_f32_16x16x32_bf16 v[176:179], v[16:19], v[24:27], v[176:179]
    s_waitcnt lgkmcnt(0)
    v_mfma_f32_16x16x32_bf16 v[180:183], v[16:19], v[28:31], v[180:183]
    s_waitcnt vmcnt(11)
    s_barrier
    ds_read_b64_tr_b16 v[0:1], v66 offset:12288
    ds_read_b64_tr_b16 v[2:3], v66 offset:13312
    ds_read_b128 v[4:7], v68 offset:14336
    ds_read_b128 v[8:11], v68 offset:55296
    ds_read_b128 v[12:15], v70 offset:14336
    ds_read_b64_tr_b16 v[16:17], v67 offset:12288
    ds_read_b64_tr_b16 v[18:19], v67 offset:13312
    ds_read_b128 v[20:23], v69 offset:14336
    ds_read_b128 v[24:27], v69 offset:55296
    ds_read_b128 v[28:31], v71 offset:14336
    s_add_u32 m0, s42, 8192
    s_mov_b32 s51, 0
    buffer_load_dwordx4 v236, s[16:19], s51 offen offset:0 lds
    buffer_load_dwordx4 v237, s[16:19], s51 offen offset:1024 lds
    buffer_load_dwordx4 v238, s[16:19], s51 offen offset:2048 lds
    buffer_load_dwordx4 v239, s[16:19], s51 offen offset:3072 lds
    s_waitcnt lgkmcnt(7)
    v_mfma_f32_16x16x32_bf16 v[172:175], v[0:3], v[4:7], v[172:175]
    s_waitcnt lgkmcnt(6)
    v_mfma_f32_16x16x32_bf16 v[176:179], v[0:3], v[8:11], v[176:179]
    s_waitcnt lgkmcnt(5)
    v_mfma_f32_16x16x32_bf16 v[180:183], v[0:3], v[12:15], v[180:183]
    s_waitcnt lgkmcnt(2)
    v_mfma_f32_16x16x32_bf16 v[172:175], v[16:19], v[20:23], v[172:175]
    s_waitcnt lgkmcnt(1)
    v_mfma_f32_16x16x32_bf16 v[176:179], v[16:19], v[24:27], v[176:179]
    s_waitcnt lgkmcnt(0)
    v_mfma_f32_16x16x32_bf16 v[180:183], v[16:19], v[28:31], v[180:183]
    s_waitcnt vmcnt(12)
    s_barrier
    ds_read_b64_tr_b16 v[0:1], v66 offset:15360
    ds_read_b64_tr_b16 v[2:3], v66 offset:16384
    ds_read_b128 v[4:7], v68 offset:17408
    ds_read_b128 v[8:11], v68 offset:58368
    ds_read_b128 v[12:15], v70 offset:17408
    ds_read_b64_tr_b16 v[16:17], v67 offset:15360
    ds_read_b64_tr_b16 v[18:19], v67 offset:16384
    ds_read_b128 v[20:23], v69 offset:17408
    ds_read_b128 v[24:27], v69 offset:58368
    ds_read_b128 v[28:31], v71 offset:17408
    s_waitcnt lgkmcnt(7)
    v_mfma_f32_16x16x32_bf16 v[172:175], v[0:3], v[4:7], v[172:175]
    s_waitcnt lgkmcnt(6)
    v_mfma_f32_16x16x32_bf16 v[176:179], v[0:3], v[8:11], v[176:179]
    s_waitcnt lgkmcnt(5)
    v_mfma_f32_16x16x32_bf16 v[180:183], v[0:3], v[12:15], v[180:183]
    s_waitcnt lgkmcnt(2)
    v_mfma_f32_16x16x32_bf16 v[172:175], v[16:19], v[20:23], v[172:175]
    s_waitcnt lgkmcnt(1)
    v_mfma_f32_16x16x32_bf16 v[176:179], v[16:19], v[24:27], v[176:179]
    s_waitcnt lgkmcnt(0)
    v_mfma_f32_16x16x32_bf16 v[180:183], v[16:19], v[28:31], v[180:183]
    s_nop 3
    v_mul_f32 v172, s52, v172
    v_mul_f32 v173, s52, v173
    v_mul_f32 v174, s52, v174
    v_mul_f32 v175, s52, v175
    v_cvt_pk_bf16_f32 v172, v172, v173
    v_cvt_pk_bf16_f32 v173, v174, v175
    ds_write_b64 v74, v[172:173] offset:18432
    v_mul_f32 v176, s52, v176
    v_mul_f32 v177, s52, v177
    v_mul_f32 v178, s52, v178
    v_mul_f32 v179, s52, v179
    v_cvt_pk_bf16_f32 v176, v176, v177
    v_cvt_pk_bf16_f32 v177, v178, v179
    ds_write_b64 v74, v[176:177] offset:18688
    v_mul_f32 v180, s52, v180
    v_mul_f32 v181, s52, v181
    v_mul_f32 v182, s52, v182
    v_mul_f32 v183, s52, v183
    v_cvt_pk_bf16_f32 v180, v180, v181
    v_cvt_pk_bf16_f32 v181, v182, v183
    ds_write_b64 v74, v[180:181] offset:18944
    s_waitcnt lgkmcnt(0)
    s_barrier
    ds_read_b128 v[108:111], v75 offset:18432
    ds_read_b128 v[124:127], v75 offset:18688
    ds_read_b128 v[140:143], v75 offset:18944
    ds_read_b128 v[112:115], v75 offset:19200
    ds_read_b128 v[128:131], v75 offset:19456
    ds_read_b128 v[144:147], v75 offset:19712
    ds_read_b128 v[116:119], v75 offset:38912
    ds_read_b128 v[132:135], v75 offset:39168
    ds_read_b128 v[148:151], v75 offset:39424
    ds_read_b128 v[120:123], v75 offset:39680
    ds_read_b128 v[136:139], v75 offset:39936
    ds_read_b128 v[152:155], v75 offset:40192
    s_add_u32 m0, s42, 12288
    s_mov_b32 s51, 4096
    buffer_load_dwordx4 v236, s[16:19], s51 offen offset:0 lds
    buffer_load_dwordx4 v237, s[16:19], s51 offen offset:1024 lds
    buffer_load_dwordx4 v238, s[16:19], s51 offen offset:2048 lds
    buffer_load_dwordx4 v239, s[16:19], s51 offen offset:3072 lds
    v_mov_b32 v0, 0
    v_mov_b32 v1, 0
    v_mov_b32 v2, 0
    v_mov_b32 v3, 0
    v_mov_b32 v4, 0
    v_mov_b32 v5, 0
    v_mov_b32 v6, 0
    v_mov_b32 v7, 0
    v_mov_b32 v8, 0
    v_mov_b32 v9, 0
    v_mov_b32 v10, 0
    v_mov_b32 v11, 0
    v_mov_b32 v12, 0
    v_mov_b32 v13, 0
    v_mov_b32 v14, 0
    v_mov_b32 v15, 0
    v_mov_b32 v16, 0
    v_mov_b32 v17, 0
    v_mov_b32 v18, 0
    v_mov_b32 v19, 0
    v_mov_b32 v20, 0
    v_mov_b32 v21, 0
    v_mov_b32 v22, 0
    v_mov_b32 v23, 0
    v_mov_b32 v24, 0
    v_mov_b32 v25, 0
    v_mov_b32 v26, 0
    v_mov_b32 v27, 0
    v_mov_b32 v28, 0
    v_mov_b32 v29, 0
    v_mov_b32 v30, 0
    v_mov_b32 v31, 0
    v_mov_b32 v64, 0
    v_mov_b32 v65, 0
    v_mov_b32 v66, 0
    v_mov_b32 v67, 0
    v_mov_b32 v68, 0
    v_mov_b32 v69, 0
    v_mov_b32 v70, 0
    v_mov_b32 v71, 0
    v_mov_b32 v72, 0
    v_mov_b32 v73, 0
    s_waitcnt lgkmcnt(0)
    v_mov_b32 v74, 0
    v_mov_b32 v75, 0
    s_barrier
    s_add_u32 m0, s42, 16384
    s_mov_b32 s51, 8192
    buffer_load_dwordx4 v236, s[12:15], s51 offen offset:0 lds
    buffer_load_dwordx4 v237, s[12:15], s51 offen offset:1024 lds
    buffer_load_dwordx4 v238, s[12:15], s51 offen offset:2048 lds
    buffer_load_dwordx4 v239, s[12:15], s51 offen offset:3072 lds
    s_waitcnt vmcnt(16)
    ds_read_b128 v[196:199], v240 offset:0
    ds_read_b128 v[200:203], v241 offset:0
    ds_read_b128 v[204:207], v242 offset:0
    ds_read_b128 v[208:211], v243 offset:0
    s_waitcnt lgkmcnt(0)
    s_add_u32 m0, s42, 0
    s_mov_b32 s51, 12288
    buffer_load_dwordx4 v236, s[12:15], s51 offen offset:0 lds
    buffer_load_dwordx4 v237, s[12:15], s51 offen offset:1024 lds
    buffer_load_dwordx4 v238, s[12:15], s51 offen offset:2048 lds
    buffer_load_dwordx4 v239, s[12:15], s51 offen offset:3072 lds
    v_mfma_f32_16x16x32_bf16 v[172:175], v[196:199], v[108:111], 0
    v_mfma_f32_16x16x32_bf16 v[176:179], v[196:199], v[124:127], 0
    v_mfma_f32_16x16x32_bf16 v[180:183], v[196:199], v[140:143], 0
    s_waitcnt vmcnt(16)
    ds_read_b128 v[196:199], v240 offset:4096
    v_mfma_f32_16x16x32_bf16 v[172:175], v[200:203], v[112:115], v[172:175]
    v_mfma_f32_16x16x32_bf16 v[176:179], v[200:203], v[128:131], v[176:179]
    v_mfma_f32_16x16x32_bf16 v[180:183], v[200:203], v[144:147], v[180:183]
    ds_read_b128 v[200:203], v241 offset:4096
    v_mfma_f32_16x16x32_bf16 v[172:175], v[204:207], v[116:119], v[172:175]
    v_mfma_f32_16x16x32_bf16 v[176:179], v[204:207], v[132:135], v[176:179]
    v_mfma_f32_16x16x32_bf16 v[180:183], v[204:207], v[148:151], v[180:183]
    ds_read_b128 v[204:207], v242 offset:4096
    v_mfma_f32_16x16x32_bf16 v[172:175], v[208:211], v[120:123], v[172:175]
    v_mfma_f32_16x16x32_bf16 v[176:179], v[208:211], v[136:139], v[176:179]
    v_mfma_f32_16x16x32_bf16 v[180:183], v[208:211], v[152:155], v[180:183]
    ds_read_b128 v[208:211], v243 offset:4096
    s_waitcnt lgkmcnt(3)
    v_mfma_f32_16x16x32_bf16 v[184:187], v[196:199], v[108:111], 0
    v_mfma_f32_16x16x32_bf16 v[188:191], v[196:199], v[124:127], 0
    v_mfma_f32_16x16x32_bf16 v[192:195], v[196:199], v[140:143], 0
    s_waitcnt lgkmcnt(2)
    v_mfma_f32_16x16x32_bf16 v[184:187], v[200:203], v[112:115], v[184:187]
    v_mfma_f32_16x16x32_bf16 v[188:191], v[200:203], v[128:131], v[188:191]
    v_mfma_f32_16x16x32_bf16 v[192:195], v[200:203], v[144:147], v[192:195]
    s_waitcnt lgkmcnt(1)
    v_mfma_f32_16x16x32_bf16 v[184:187], v[204:207], v[116:119], v[184:187]
    v_mfma_f32_16x16x32_bf16 v[188:191], v[204:207], v[132:135], v[188:191]
    v_mfma_f32_16x16x32_bf16 v[192:195], v[204:207], v[148:151], v[192:195]
    s_waitcnt lgkmcnt(0)
    s_add_u32 m0, s42, 4096
    s_mov_b32 s51, 8192
    buffer_load_dwordx4 v236, s[16:19], s51 offen offset:0 lds
    buffer_load_dwordx4 v237, s[16:19], s51 offen offset:1024 lds
    buffer_load_dwordx4 v238, s[16:19], s51 offen offset:2048 lds
    buffer_load_dwordx4 v239, s[16:19], s51 offen offset:3072 lds
    v_mfma_f32_16x16x32_bf16 v[184:187], v[208:211], v[120:123], v[184:187]
    v_mfma_f32_16x16x32_bf16 v[188:191], v[208:211], v[136:139], v[188:191]
    v_mfma_f32_16x16x32_bf16 v[192:195], v[208:211], v[152:155], v[192:195]
    s_waitcnt vmcnt(16)
    ds_read_b64_tr_b16 v[196:197], v244 offset:8192
    ds_read_b64_tr_b16 v[200:201], v245 offset:8192
    ds_read_b64_tr_b16 v[212:213], v246 offset:8192
    ds_read_b64_tr_b16 v[216:217], v247 offset:8192
    ds_read_b64_tr_b16 v[220:221], v248 offset:8192
    ds_read_b64_tr_b16 v[224:225], v249 offset:8192
    ds_read_b64_tr_b16 v[228:229], v250 offset:8192
    ds_read_b64_tr_b16 v[232:233], v251 offset:8192
    v_max3_f32 v252, v172, v173, v174
    v_max3_f32 v252, v252, v175, v184
    v_max3_f32 v252, v252, v185, v186
    v_max_f32 v252, v252, v187
    v_mov_b32 v253, v252
    s_nop 1
    v_permlane32_swap_b32 v252, v253
    v_max_f32 v252, v252, v253
    v_mov_b32 v253, v252
    s_nop 1
    v_permlane16_swap_b32 v252, v253
    v_max_f32 v252, v252, v253
    v_sub_f32 v172, v172, v252
    v_sub_f32 v173, v173, v252
    v_sub_f32 v174, v174, v252
    v_sub_f32 v175, v175, v252
    v_sub_f32 v184, v184, v252
    v_sub_f32 v185, v185, v252
    v_sub_f32 v186, v186, v252
    v_sub_f32 v187, v187, v252
    v_sub_f32 v156, 0, v252
    v_sub_f32 v157, 0, v252
    v_sub_f32 v158, 0, v252
    v_sub_f32 v159, 0, v252
    v_max3_f32 v252, v176, v177, v178
    v_max3_f32 v252, v252, v179, v188
    v_max3_f32 v252, v252, v189, v190
    v_max_f32 v252, v252, v191
    v_mov_b32 v253, v252
    s_nop 1
    v_permlane32_swap_b32 v252, v253
    v_max_f32 v252, v252, v253
    v_mov_b32 v253, v252
    s_nop 1
    v_permlane16_swap_b32 v252, v253
    v_max_f32 v252, v252, v253
    v_sub_f32 v176, v176, v252
    v_sub_f32 v177, v177, v252
    v_sub_f32 v178, v178, v252
    v_sub_f32 v179, v179, v252
    v_sub_f32 v188, v188, v252
    v_sub_f32 v189, v189, v252
    v_sub_f32 v190, v190, v252
    v_sub_f32 v191, v191, v252
    v_sub_f32 v160, 0, v252
    v_sub_f32 v161, 0, v252
    v_sub_f32 v162, 0, v252
    v_sub_f32 v163, 0, v252
    v_max3_f32 v252, v180, v181, v182
    v_max3_f32 v252, v252, v183, v192
    v_max3_f32 v252, v252, v193, v194
    v_max_f32 v252, v252, v195
    v_mov_b32 v253, v252
    s_nop 1
    v_permlane32_swap_b32 v252, v253
    v_max_f32 v252, v252, v253
    v_mov_b32 v253, v252
    s_nop 1
    v_permlane16_swap_b32 v252, v253
    v_max_f32 v252, v252, v253
    v_sub_f32 v180, v180, v252
    v_sub_f32 v181, v181, v252
    v_sub_f32 v182, v182, v252
    v_sub_f32 v183, v183, v252
    v_sub_f32 v192, v192, v252
    v_sub_f32 v193, v193, v252
    v_sub_f32 v194, v194, v252
    v_sub_f32 v195, v195, v252
    v_sub_f32 v164, 0, v252
    v_sub_f32 v165, 0, v252
    v_sub_f32 v166, 0, v252
    v_sub_f32 v167, 0, v252
    v_exp_f32 v172, v172
    v_exp_f32 v173, v173
    v_exp_f32 v174, v174
    v_exp_f32 v175, v175
    v_exp_f32 v184, v184
    v_exp_f32 v185, v185
    v_exp_f32 v186, v186
    v_exp_f32 v187, v187
    v_cvt_pk_bf16_f32 v172, v172, v173
    v_cvt_pk_bf16_f32 v173, v174, v175
    v_cvt_pk_bf16_f32 v174, v184, v185
    v_cvt_pk_bf16_f32 v175, v186, v187
    s_waitcnt lgkmcnt(0)
    s_add_u32 m0, s42, 8192
    s_mov_b32 s51, 12288
    buffer_load_dwordx4 v236, s[16:19], s51 offen offset:0 lds
    buffer_load_dwordx4 v237, s[16:19], s51 offen offset:1024 lds
    buffer_load_dwordx4 v238, s[16:19], s51 offen offset:2048 lds
    buffer_load_dwordx4 v239, s[16:19], s51 offen offset:3072 lds
    s_waitcnt vmcnt(16)
    ds_read_b64_tr_b16 v[198:199], v244 offset:12288
    ds_read_b64_tr_b16 v[202:203], v245 offset:12288
    ds_read_b64_tr_b16 v[214:215], v246 offset:12288
    ds_read_b64_tr_b16 v[218:219], v247 offset:12288
    ds_read_b64_tr_b16 v[222:223], v248 offset:12288
    ds_read_b64_tr_b16 v[226:227], v249 offset:12288
    ds_read_b64_tr_b16 v[230:231], v250 offset:12288
    ds_read_b64_tr_b16 v[234:235], v251 offset:12288
    v_exp_f32 v176, v176
    v_exp_f32 v177, v177
    v_exp_f32 v178, v178
    v_exp_f32 v179, v179
    v_exp_f32 v188, v188
    v_exp_f32 v189, v189
    v_exp_f32 v190, v190
    v_exp_f32 v191, v191
    v_cvt_pk_bf16_f32 v176, v176, v177
    v_cvt_pk_bf16_f32 v177, v178, v179
    v_cvt_pk_bf16_f32 v178, v188, v189
    v_cvt_pk_bf16_f32 v179, v190, v191
    v_exp_f32 v180, v180
    v_exp_f32 v181, v181
    v_exp_f32 v182, v182
    v_exp_f32 v183, v183
    v_exp_f32 v192, v192
    v_exp_f32 v193, v193
    v_exp_f32 v194, v194
    v_exp_f32 v195, v195
    v_cvt_pk_bf16_f32 v180, v180, v181
    v_cvt_pk_bf16_f32 v181, v182, v183
    v_cvt_pk_bf16_f32 v182, v192, v193
    v_cvt_pk_bf16_f32 v183, v194, v195
    v_mfma_f32_16x16x32_bf16 v[96:99], v[168:171], v[172:175], v[96:99]
    v_mfma_f32_16x16x32_bf16 v[100:103], v[168:171], v[176:179], v[100:103]
    v_mfma_f32_16x16x32_bf16 v[104:107], v[168:171], v[180:183], v[104:107]
    s_waitcnt lgkmcnt(0)
    s_add_u32 m0, s42, 12288
    s_mov_b32 s51, 16384
    buffer_load_dwordx4 v236, s[12:15], s51 offen offset:0 lds
    buffer_load_dwordx4 v237, s[12:15], s51 offen offset:1024 lds
    buffer_load_dwordx4 v238, s[12:15], s51 offen offset:2048 lds
    buffer_load_dwordx4 v239, s[12:15], s51 offen offset:3072 lds
    v_mfma_f32_16x16x32_bf16 v[0:3], v[196:199], v[172:175], v[0:3]
    v_mfma_f32_16x16x32_bf16 v[4:7], v[196:199], v[176:179], v[4:7]
    v_mfma_f32_16x16x32_bf16 v[8:11], v[196:199], v[180:183], v[8:11]
    v_mfma_f32_16x16x32_bf16 v[12:15], v[200:203], v[172:175], v[12:15]
    v_mfma_f32_16x16x32_bf16 v[16:19], v[200:203], v[176:179], v[16:19]
    v_mfma_f32_16x16x32_bf16 v[20:23], v[200:203], v[180:183], v[20:23]
    v_mfma_f32_16x16x32_bf16 v[24:27], v[212:215], v[172:175], v[24:27]
    v_mfma_f32_16x16x32_bf16 v[28:31], v[212:215], v[176:179], v[28:31]
    v_mfma_f32_16x16x32_bf16 v[32:35], v[212:215], v[180:183], v[32:35]
    v_mfma_f32_16x16x32_bf16 v[36:39], v[216:219], v[172:175], v[36:39]
    v_mfma_f32_16x16x32_bf16 v[40:43], v[216:219], v[176:179], v[40:43]
    v_mfma_f32_16x16x32_bf16 v[44:47], v[216:219], v[180:183], v[44:47]
    s_waitcnt vmcnt(16)
    ds_read_b128 v[196:199], v240 offset:16384
    ds_read_b128 v[200:203], v241 offset:16384
    ds_read_b128 v[204:207], v242 offset:16384
    ds_read_b128 v[208:211], v243 offset:16384
    v_mfma_f32_16x16x32_bf16 v[48:51], v[220:223], v[172:175], v[48:51]
    v_mfma_f32_16x16x32_bf16 v[52:55], v[220:223], v[176:179], v[52:55]
    v_mfma_f32_16x16x32_bf16 v[56:59], v[220:223], v[180:183], v[56:59]
    v_mfma_f32_16x16x32_bf16 v[60:63], v[224:227], v[172:175], v[60:63]
    v_mfma_f32_16x16x32_bf16 v[64:67], v[224:227], v[176:179], v[64:67]
    v_mfma_f32_16x16x32_bf16 v[68:71], v[224:227], v[180:183], v[68:71]
    v_mfma_f32_16x16x32_bf16 v[72:75], v[228:231], v[172:175], v[72:75]
    v_mfma_f32_16x16x32_bf16 v[76:79], v[228:231], v[176:179], v[76:79]
    v_mfma_f32_16x16x32_bf16 v[80:83], v[228:231], v[180:183], v[80:83]
    s_waitcnt lgkmcnt(0)
    s_add_u32 m0, s42, 16384
    s_mov_b32 s51, 20480
    buffer_load_dwordx4 v236, s[12:15], s51 offen offset:0 lds
    buffer_load_dwordx4 v237, s[12:15], s51 offen offset:1024 lds
    buffer_load_dwordx4 v238, s[12:15], s51 offen offset:2048 lds
    buffer_load_dwordx4 v239, s[12:15], s51 offen offset:3072 lds
    v_mfma_f32_16x16x32_bf16 v[84:87], v[232:235], v[172:175], v[84:87]
    v_mfma_f32_16x16x32_bf16 v[88:91], v[232:235], v[176:179], v[88:91]
    v_mfma_f32_16x16x32_bf16 v[92:95], v[232:235], v[180:183], v[92:95]
    v_mfma_f32_16x16x32_bf16 v[172:175], v[196:199], v[108:111], v[156:159]
    v_mfma_f32_16x16x32_bf16 v[176:179], v[196:199], v[124:127], v[160:163]
    v_mfma_f32_16x16x32_bf16 v[180:183], v[196:199], v[140:143], v[164:167]
    s_waitcnt vmcnt(16)
    ds_read_b128 v[196:199], v240 offset:0
    v_mfma_f32_16x16x32_bf16 v[172:175], v[200:203], v[112:115], v[172:175]
    v_mfma_f32_16x16x32_bf16 v[176:179], v[200:203], v[128:131], v[176:179]
    v_mfma_f32_16x16x32_bf16 v[180:183], v[200:203], v[144:147], v[180:183]
    ds_read_b128 v[200:203], v241 offset:0
    v_mfma_f32_16x16x32_bf16 v[172:175], v[204:207], v[116:119], v[172:175]
    v_mfma_f32_16x16x32_bf16 v[176:179], v[204:207], v[132:135], v[176:179]
    v_mfma_f32_16x16x32_bf16 v[180:183], v[204:207], v[148:151], v[180:183]
    ds_read_b128 v[204:207], v242 offset:0
    v_mfma_f32_16x16x32_bf16 v[172:175], v[208:211], v[120:123], v[172:175]
    v_mfma_f32_16x16x32_bf16 v[176:179], v[208:211], v[136:139], v[176:179]
    v_mfma_f32_16x16x32_bf16 v[180:183], v[208:211], v[152:155], v[180:183]
    ds_read_b128 v[208:211], v243 offset:0
    s_waitcnt lgkmcnt(3)
    v_mfma_f32_16x16x32_bf16 v[184:187], v[196:199], v[108:111], v[156:159]
    v_mfma_f32_16x16x32_bf16 v[188:191], v[196:199], v[124:127], v[160:163]
    v_mfma_f32_16x16x32_bf16 v[192:195], v[196:199], v[140:143], v[164:167]
    s_waitcnt lgkmcnt(2)
    v_mfma_f32_16x16x32_bf16 v[184:187], v[200:203], v[112:115], v[184:187]
    v_mfma_f32_16x16x32_bf16 v[188:191], v[200:203], v[128:131], v[188:191]
    v_mfma_f32_16x16x32_bf16 v[192:195], v[200:203], v[144:147], v[192:195]
    s_waitcnt lgkmcnt(1)
    v_mfma_f32_16x16x32_bf16 v[184:187], v[204:207], v[116:119], v[184:187]
    v_mfma_f32_16x16x32_bf16 v[188:191], v[204:207], v[132:135], v[188:191]
    v_mfma_f32_16x16x32_bf16 v[192:195], v[204:207], v[148:151], v[192:195]
    s_waitcnt lgkmcnt(0)
    s_add_u32 m0, s42, 0
    s_mov_b32 s51, 16384
    buffer_load_dwordx4 v236, s[16:19], s51 offen offset:0 lds
    buffer_load_dwordx4 v237, s[16:19], s51 offen offset:1024 lds
    buffer_load_dwordx4 v238, s[16:19], s51 offen offset:2048 lds
    buffer_load_dwordx4 v239, s[16:19], s51 offen offset:3072 lds
    v_mfma_f32_16x16x32_bf16 v[184:187], v[208:211], v[120:123], v[184:187]
    v_mfma_f32_16x16x32_bf16 v[188:191], v[208:211], v[136:139], v[188:191]
    v_mfma_f32_16x16x32_bf16 v[192:195], v[208:211], v[152:155], v[192:195]
    s_waitcnt vmcnt(16)
    ds_read_b64_tr_b16 v[196:197], v244 offset:4096
    ds_read_b64_tr_b16 v[200:201], v245 offset:4096
    ds_read_b64_tr_b16 v[212:213], v246 offset:4096
    ds_read_b64_tr_b16 v[216:217], v247 offset:4096
    ds_read_b64_tr_b16 v[220:221], v248 offset:4096
    ds_read_b64_tr_b16 v[224:225], v249 offset:4096
    ds_read_b64_tr_b16 v[228:229], v250 offset:4096
    ds_read_b64_tr_b16 v[232:233], v251 offset:4096
    v_max3_f32 v252, v172, v173, v174
    v_max3_f32 v253, v175, v176, v177
    v_max3_f32 v252, v252, v178, v179
    v_max3_f32 v253, v253, v180, v181
    v_max3_f32 v252, v252, v182, v183
    v_max3_f32 v253, v253, v184, v185
    v_max3_f32 v252, v252, v186, v187
    v_max3_f32 v253, v253, v188, v189
    v_max3_f32 v252, v252, v190, v191
    v_max3_f32 v253, v253, v192, v193
    v_max3_f32 v252, v252, v194, v195
    v_max_f32 v252, v252, v253
    v_cmp_lt_f32 vcc, s53, v252
    s_cbranch_vccnz K1_RARE1
K1_BACK1:
    v_exp_f32 v172, v172
    v_exp_f32 v173, v173
    v_exp_f32 v174, v174
    v_exp_f32 v175, v175
    v_exp_f32 v184, v184
    v_exp_f32 v185, v185
    v_exp_f32 v186, v186
    v_exp_f32 v187, v187
    v_cvt_pk_bf16_f32 v172, v172, v173
    v_cvt_pk_bf16_f32 v173, v174, v175
    v_cvt_pk_bf16_f32 v174, v184, v185
    v_cvt_pk_bf16_f32 v175, v186, v187
    s_waitcnt lgkmcnt(0)
    s_add_u32 m0, s42, 4096
    s_mov_b32 s51, 20480
    buffer_load_dwordx4 v236, s[16:19], s51 offen offset:0 lds
    buffer_load_dwordx4 v237, s[16:19], s51 offen offset:1024 lds
    buffer_load_dwordx4 v238, s[16:19], s51 offen offset:2048 lds
    buffer_load_dwordx4 v239, s[16:19], s51 offen offset:3072 lds
    s_waitcnt vmcnt(16)
    ds_read_b64_tr_b16 v[198:199], v244 offset:8192
    ds_read_b64_tr_b16 v[202:203], v245 offset:8192
    ds_read_b64_tr_b16 v[214:215], v246 offset:8192
    ds_read_b64_tr_b16 v[218:219], v247 offset:8192
    ds_read_b64_tr_b16 v[222:223], v248 offset:8192
    ds_read_b64_tr_b16 v[226:227], v249 offset:8192
    ds_read_b64_tr_b16 v[230:231], v250 offset:8192
    ds_read_b64_tr_b16 v[234:235], v251 offset:8192
    v_exp_f32 v176, v176
    v_exp_f32 v177, v177
    v_exp_f32 v178, v178
    v_exp_f32 v179, v179
    v_exp_f32 v188, v188
    v_exp_f32 v189, v189
    v_exp_f32 v190, v190
    v_exp_f32 v191, v191
    v_cvt_pk_bf16_f32 v176, v176, v177
    v_cvt_pk_bf16_f32 v177, v178, v179
    v_cvt_pk_bf16_f32 v178, v188, v189
    v_cvt_pk_bf16_f32 v179, v190, v191
    v_exp_f32 v180, v180
    v_exp_f32 v181, v181
    v_exp_f32 v182, v182
    v_exp_f32 v183, v183
    v_exp_f32 v192, v192
    v_exp_f32 v193, v193
    v_exp_f32 v194, v194
    v_exp_f32 v195, v195
    v_cvt_pk_bf16_f32 v180, v180, v181
    v_cvt_pk_bf16_f32 v181, v182, v183
    v_cvt_pk_bf16_f32 v182, v192, v193
    v_cvt_pk_bf16_f32 v183, v194, v195
    v_mfma_f32_16x16x32_bf16 v[96:99], v[168:171], v[172:175], v[96:99]
    v_mfma_f32_16x16x32_bf16 v[100:103], v[168:171], v[176:179], v[100:103]
    v_mfma_f32_16x16x32_bf16 v[104:107], v[168:171], v[180:183], v[104:107]
    s_waitcnt lgkmcnt(0)
    s_add_u32 m0, s42, 8192
    s_mov_b32 s51, 24576
    buffer_load_dwordx4 v236, s[12:15], s51 offen offset:0 lds
    buffer_load_dwordx4 v237, s[12:15], s51 offen offset:1024 lds
    buffer_load_dwordx4 v238, s[12:15], s51 offen offset:2048 lds
    buffer_load_dwordx4 v239, s[12:15], s51 offen offset:3072 lds
    v_mfma_f32_16x16x32_bf16 v[0:3], v[196:199], v[172:175], v[0:3]
    v_mfma_f32_16x16x32_bf16 v[4:7], v[196:199], v[176:179], v[4:7]
    v_mfma_f32_16x16x32_bf16 v[8:11], v[196:199], v[180:183], v[8:11]
    v_mfma_f32_16x16x32_bf16 v[12:15], v[200:203], v[172:175], v[12:15]
    v_mfma_f32_16x16x32_bf16 v[16:19], v[200:203], v[176:179], v[16:19]
    v_mfma_f32_16x16x32_bf16 v[20:23], v[200:203], v[180:183], v[20:23]
    v_mfma_f32_16x16x32_bf16 v[24:27], v[212:215], v[172:175], v[24:27]
    v_mfma_f32_16x16x32_bf16 v[28:31], v[212:215], v[176:179], v[28:31]
    v_mfma_f32_16x16x32_bf16 v[32:35], v[212:215], v[180:183], v[32:35]
    v_mfma_f32_16x16x32_bf16 v[36:39], v[216:219], v[172:175], v[36:39]
    v_mfma_f32_16x16x32_bf16 v[40:43], v[216:219], v[176:179], v[40:43]
    v_mfma_f32_16x16x32_bf16 v[44:47], v[216:219], v[180:183], v[44:47]
    s_waitcnt vmcnt(16)
    ds_read_b128 v[196:199], v240 offset:12288
    ds_read_b128 v[200:203], v241 offset:12288
    ds_read_b128 v[204:207], v242 offset:12288
    ds_read_b128 v[208:211], v243 offset:12288
    v_mfma_f32_16x16x32_bf16 v[48:51], v[220:223], v[172:175], v[48:51]
    v_mfma_f32_16x16x32_bf16 v[52:55], v[220:223], v[176:179], v[52:55]
    v_mfma_f32_16x16x32_bf16 v[56:59], v[220:223], v[180:183], v[56:59]
    v_mfma_f32_16x16x32_bf16 v[60:63], v[224:227], v[172:175], v[60:63]
    v_mfma_f32_16x16x32_bf16 v[64:67], v[224:227], v[176:179], v[64:67]
    v_mfma_f32_16x16x32_bf16 v[68:71], v[224:227], v[180:183], v[68:71]
    v_mfma_f32_16x16x32_bf16 v[72:75], v[228:231], v[172:175], v[72:75]
    v_mfma_f32_16x16x32_bf16 v[76:79], v[228:231], v[176:179], v[76:79]
    v_mfma_f32_16x16x32_bf16 v[80:83], v[228:231], v[180:183], v[80:83]
    s_waitcnt lgkmcnt(0)
    s_add_u32 m0, s42, 12288
    s_mov_b32 s51, 28672
    buffer_load_dwordx4 v236, s[12:15], s51 offen offset:0 lds
    buffer_load_dwordx4 v237, s[12:15], s51 offen offset:1024 lds
    buffer_load_dwordx4 v238, s[12:15], s51 offen offset:2048 lds
    buffer_load_dwordx4 v239, s[12:15], s51 offen offset:3072 lds
    v_mfma_f32_16x16x32_bf16 v[84:87], v[232:235], v[172:175], v[84:87]
    v_mfma_f32_16x16x32_bf16 v[88:91], v[232:235], v[176:179], v[88:91]
    v_mfma_f32_16x16x32_bf16 v[92:95], v[232:235], v[180:183], v[92:95]
    v_mfma_f32_16x16x32_bf16 v[172:175], v[196:199], v[108:111], v[156:159]
    v_mfma_f32_16x16x32_bf16 v[176:179], v[196:199], v[124:127], v[160:163]
    v_mfma_f32_16x16x32_bf16 v[180:183], v[196:199], v[140:143], v[164:167]
    s_waitcnt vmcnt(16)
    ds_read_b128 v[196:199], v240 offset:16384
    v_mfma_f32_16x16x32_bf16 v[172:175], v[200:203], v[112:115], v[172:175]
    v_mfma_f32_16x16x32_bf16 v[176:179], v[200:203], v[128:131], v[176:179]
    v_mfma_f32_16x16x32_bf16 v[180:183], v[200:203], v[144:147], v[180:183]
    ds_read_b128 v[200:203], v241 offset:16384
    v_mfma_f32_16x16x32_bf16 v[172:175], v[204:207], v[116:119], v[172:175]
    v_mfma_f32_16x16x32_bf16 v[176:179], v[204:207], v[132:135], v[176:179]
    v_mfma_f32_16x16x32_bf16 v[180:183], v[204:207], v[148:151], v[180:183]
    ds_read_b128 v[204:207], v242 offset:16384
    v_mfma_f32_16x16x32_bf16 v[172:175], v[208:211], v[120:123], v[172:175]
    v_mfma_f32_16x16x32_bf16 v[176:179], v[208:211], v[136:139], v[176:179]
    v_mfma_f32_16x16x32_bf16 v[180:183], v[208:211], v[152:155], v[180:183]
    ds_read_b128 v[208:211], v243 offset:16384
    s_waitcnt lgkmcnt(3)
    v_mfma_f32_16x16x32_bf16 v[184:187], v[196:199], v[108:111], v[156:159]
    v_mfma_f32_16x16x32_bf16 v[188:191], v[196:199], v[124:127], v[160:163]
    v_mfma_f32_16x16x32_bf16 v[192:195], v[196:199], v[140:143], v[164:167]
    s_waitcnt lgkmcnt(2)
    v_mfma_f32_16x16x32_bf16 v[184:187], v[200:203], v[112:115], v[184:187]
    v_mfma_f32_16x16x32_bf16 v[188:191], v[200:203], v[128:131], v[188:191]
    v_mfma_f32_16x16x32_bf16 v[192:195], v[200:203], v[144:147], v[192:195]
    s_waitcnt lgkmcnt(1)
    v_mfma_f32_16x16x32_bf16 v[184:187], v[204:207], v[116:119], v[184:187]
    v_mfma_f32_16x16x32_bf16 v[188:191], v[204:207], v[132:135], v[188:191]
    v_mfma_f32_16x16x32_bf16 v[192:195], v[204:207], v[148:151], v[192:195]
    s_waitcnt lgkmcnt(0)
    s_add_u32 m0, s42, 16384
    s_mov_b32 s51, 24576
    buffer_load_dwordx4 v236, s[16:19], s51 offen offset:0 lds
    buffer_load_dwordx4 v237, s[16:19], s51 offen offset:1024 lds
    buffer_load_dwordx4 v238, s[16:19], s51 offen offset:2048 lds
    buffer_load_dwordx4 v239, s[16:19], s51 offen offset:3072 lds
    v_mfma_f32_16x16x32_bf16 v[184:187], v[208:211], v[120:123], v[184:187]
    v_mfma_f32_16x16x32_bf16 v[188:191], v[208:211], v[136:139], v[188:191]
    v_mfma_f32_16x16x32_bf16 v[192:195], v[208:211], v[152:155], v[192:195]
    s_waitcnt vmcnt(16)
    ds_read_b64_tr_b16 v[196:197], v244 offset:0
    ds_read_b64_tr_b16 v[200:201], v245 offset:0
    ds_read_b64_tr_b16 v[212:213], v246 offset:0
    ds_read_b64_tr_b16 v[216:217], v247 offset:0
    ds_read_b64_tr_b16 v[220:221], v248 offset:0
    ds_read_b64_tr_b16 v[224:225], v249 offset:0
    ds_read_b64_tr_b16 v[228:229], v250 offset:0
    ds_read_b64_tr_b16 v[232:233], v251 offset:0
    v_max3_f32 v252, v172, v173, v174
    v_max3_f32 v253, v175, v176, v177
    v_max3_f32 v252, v252, v178, v179
    v_max3_f32 v253, v253, v180, v181
    v_max3_f32 v252, v252, v182, v183
    v_max3_f32 v253, v253, v184, v185
    v_max3_f32 v252, v252, v186, v187
    v_max3_f32 v253, v253, v188, v189
    v_max3_f32 v252, v252, v190, v191
    v_max3_f32 v253, v253, v192, v193
    v_max3_f32 v252, v252, v194, v195
    v_max_f32 v252, v252, v253
    v_cmp_lt_f32 vcc, s53, v252
    s_cbranch_vccnz K1_RARE2
K1_BACK2:
    v_exp_f32 v172, v172
    v_exp_f32 v173, v173
    v_exp_f32 v174, v174
    v_exp_f32 v175, v175
    v_exp_f32 v184, v184
    v_exp_f32 v185, v185
    v_exp_f32 v186, v186
    v_exp_f32 v187, v187
    v_cvt_pk_bf16_f32 v172, v172, v173
    v_cvt_pk_bf16_f32 v173, v174, v175
    v_cvt_pk_bf16_f32 v174, v184, v185
    v_cvt_pk_bf16_f32 v175, v186, v187
    s_waitcnt lgkmcnt(0)
    s_add_u32 m0, s42, 0
    s_mov_b32 s51, 28672
    buffer_load_dwordx4 v236, s[16:19], s51 offen offset:0 lds
    buffer_load_dwordx4 v237, s[16:19], s51 offen offset:1024 lds
    buffer_load_dwordx4 v238, s[16:19], s51 offen offset:2048 lds
    buffer_load_dwordx4 v239, s[16:19], s51 offen offset:3072 lds
    s_waitcnt vmcnt(16)
    ds_read_b64_tr_b16 v[198:199], v244 offset:4096
    ds_read_b64_tr_b16 v[202:203], v245 offset:4096
    ds_read_b64_tr_b16 v[214:215], v246 offset:4096
    ds_read_b64_tr_b16 v[218:219], v247 offset:4096
    ds_read_b64_tr_b16 v[222:223], v248 offset:4096
    ds_read_b64_tr_b16 v[226:227], v249 offset:4096
    ds_read_b64_tr_b16 v[230:231], v250 offset:4096
    ds_read_b64_tr_b16 v[234:235], v251 offset:4096
    v_exp_f32 v176, v176
    v_exp_f32 v177, v177
    v_exp_f32 v178, v178
    v_exp_f32 v179, v179
    v_exp_f32 v188, v188
    v_exp_f32 v189, v189
    v_exp_f32 v190, v190
    v_exp_f32 v191, v191
    v_cvt_pk_bf16_f32 v176, v176, v177
    v_cvt_pk_bf16_f32 v177, v178, v179
    v_cvt_pk_bf16_f32 v178, v188, v189
    v_cvt_pk_bf16_f32 v179, v190, v191
    v_exp_f32 v180, v180
    v_exp_f32 v181, v181
    v_exp_f32 v182, v182
    v_exp_f32 v183, v183
    v_exp_f32 v192, v192
    v_exp_f32 v193, v193
    v_exp_f32 v194, v194
    v_exp_f32 v195, v195
    v_cvt_pk_bf16_f32 v180, v180, v181
    v_cvt_pk_bf16_f32 v181, v182, v183
    v_cvt_pk_bf16_f32 v182, v192, v193
    v_cvt_pk_bf16_f32 v183, v194, v195
    v_mfma_f32_16x16x32_bf16 v[96:99], v[168:171], v[172:175], v[96:99]
    v_mfma_f32_16x16x32_bf16 v[100:103], v[168:171], v[176:179], v[100:103]
    v_mfma_f32_16x16x32_bf16 v[104:107], v[168:171], v[180:183], v[104:107]
    s_waitcnt lgkmcnt(0)
    s_add_u32 m0, s42, 4096
    s_mov_b32 s51, 32768
    buffer_load_dwordx4 v236, s[12:15], s51 offen offset:0 lds
    buffer_load_dwordx4 v237, s[12:15], s51 offen offset:1024 lds
    buffer_load_dwordx4 v238, s[12:15], s51 offen offset:2048 lds
    buffer_load_dwordx4 v239, s[12:15], s51 offen offset:3072 lds
    v_mfma_f32_16x16x32_bf16 v[0:3], v[196:199], v[172:175], v[0:3]
    v_mfma_f32_16x16x32_bf16 v[4:7], v[196:199], v[176:179], v[4:7]
    v_mfma_f32_16x16x32_bf16 v[8:11], v[196:199], v[180:183], v[8:11]
    v_mfma_f32_16x16x32_bf16 v[12:15], v[200:203], v[172:175], v[12:15]
    v_mfma_f32_16x16x32_bf16 v[16:19], v[200:203], v[176:179], v[16:19]
    v_mfma_f32_16x16x32_bf16 v[20:23], v[200:203], v[180:183], v[20:23]
    v_mfma_f32_16x16x32_bf16 v[24:27], v[212:215], v[172:175], v[24:27]
    v_mfma_f32_16x16x32_bf16 v[28:31], v[212:215], v[176:179], v[28:31]
    v_mfma_f32_16x16x32_bf16 v[32:35], v[212:215], v[180:183], v[32:35]
    v_mfma_f32_16x16x32_bf16 v[36:39], v[216:219], v[172:175], v[36:39]
    v_mfma_f32_16x16x32_bf16 v[40:43], v[216:219], v[176:179], v[40:43]
    v_mfma_f32_16x16x32_bf16 v[44:47], v[216:219], v[180:183], v[44:47]
    s_waitcnt vmcnt(16)
    ds_read_b128 v[196:199], v240 offset:8192
    ds_read_b128 v[200:203], v241 offset:8192
    ds_read_b128 v[204:207], v242 offset:8192
    ds_read_b128 v[208:211], v243 offset:8192
    v_mfma_f32_16x16x32_bf16 v[48:51], v[220:223], v[172:175], v[48:51]
    v_mfma_f32_16x16x32_bf16 v[52:55], v[220:223], v[176:179], v[52:55]
    v_mfma_f32_16x16x32_bf16 v[56:59], v[220:223], v[180:183], v[56:59]
    v_mfma_f32_16x16x32_bf16 v[60:63], v[224:227], v[172:175], v[60:63]
    v_mfma_f32_16x16x32_bf16 v[64:67], v[224:227], v[176:179], v[64:67]
    v_mfma_f32_16x16x32_bf16 v[68:71], v[224:227], v[180:183], v[68:71]
    v_mfma_f32_16x16x32_bf16 v[72:75], v[228:231], v[172:175], v[72:75]
    v_mfma_f32_16x16x32_bf16 v[76:79], v[228:231], v[176:179], v[76:79]
    v_mfma_f32_16x16x32_bf16 v[80:83], v[228:231], v[180:183], v[80:83]
    s_waitcnt lgkmcnt(0)
    s_add_u32 m0, s42, 8192
    s_mov_b32 s51, 36864
    buffer_load_dwordx4 v236, s[12:15], s51 offen offset:0 lds
    buffer_load_dwordx4 v237, s[12:15], s51 offen offset:1024 lds
    buffer_load_dwordx4 v238, s[12:15], s51 offen offset:2048 lds
    buffer_load_dwordx4 v239, s[12:15], s51 offen offset:3072 lds
    v_mfma_f32_16x16x32_bf16 v[84:87], v[232:235], v[172:175], v[84:87]
    v_mfma_f32_16x16x32_bf16 v[88:91], v[232:235], v[176:179], v[88:91]
    v_mfma_f32_16x16x32_bf16 v[92:95], v[232:235], v[180:183], v[92:95]
    v_mfma_f32_16x16x32_bf16 v[172:175], v[196:199], v[108:111], v[156:159]
    v_mfma_f32_16x16x32_bf16 v[176:179], v[196:199], v[124:127], v[160:163]
    v_mfma_f32_16x16x32_bf16 v[180:183], v[196:199], v[140:143], v[164:167]
    s_waitcnt vmcnt(16)
    ds_read_b128 v[196:199], v240 offset:12288
    v_mfma_f32_16x16x32_bf16 v[172:175], v[200:203], v[112:115], v[172:175]
    v_mfma_f32_16x16x32_bf16 v[176:179], v[200:203], v[128:131], v[176:179]
    v_mfma_f32_16x16x32_bf16 v[180:183], v[200:203], v[144:147], v[180:183]
    ds_read_b128 v[200:203], v241 offset:12288
    v_mfma_f32_16x16x32_bf16 v[172:175], v[204:207], v[116:119], v[172:175]
    v_mfma_f32_16x16x32_bf16 v[176:179], v[204:207], v[132:135], v[176:179]
    v_mfma_f32_16x16x32_bf16 v[180:183], v[204:207], v[148:151], v[180:183]
    ds_read_b128 v[204:207], v242 offset:12288
    v_mfma_f32_16x16x32_bf16 v[172:175], v[208:211], v[120:123], v[172:175]
    v_mfma_f32_16x16x32_bf16 v[176:179], v[208:211], v[136:139], v[176:179]
    v_mfma_f32_16x16x32_bf16 v[180:183], v[208:211], v[152:155], v[180:183]
    ds_read_b128 v[208:211], v243 offset:12288
    s_waitcnt lgkmcnt(3)
    v_mfma_f32_16x16x32_bf16 v[184:187], v[196:199], v[108:111], v[156:159]
    v_mfma_f32_16x16x32_bf16 v[188:191], v[196:199], v[124:127], v[160:163]
    v_mfma_f32_16x16x32_bf16 v[192:195], v[196:199], v[140:143], v[164:167]
    s_waitcnt lgkmcnt(2)
    v_mfma_f32_16x16x32_bf16 v[184:187], v[200:203], v[112:115], v[184:187]
    v_mfma_f32_16x16x32_bf16 v[188:191], v[200:203], v[128:131], v[188:191]
    v_mfma_f32_16x16x32_bf16 v[192:195], v[200:203], v[144:147], v[192:195]
    s_waitcnt lgkmcnt(1)
    v_mfma_f32_16x16x32_bf16 v[184:187], v[204:207], v[116:119], v[184:187]
    v_mfma_f32_16x16x32_bf16 v[188:191], v[204:207], v[132:135], v[188:191]
    v_mfma_f32_16x16x32_bf16 v[192:195], v[204:207], v[148:151], v[192:195]
    s_waitcnt lgkmcnt(0)
    s_add_u32 m0, s42, 12288
    s_mov_b32 s51, 32768
    buffer_load_dwordx4 v236, s[16:19], s51 offen offset:0 lds
    buffer_load_dwordx4 v237, s[16:19], s51 offen offset:1024 lds
    buffer_load_dwordx4 v238, s[16:19], s51 offen offset:2048 lds
    buffer_load_dwordx4 v239, s[16:19], s51 offen offset:3072 lds
    v_mfma_f32_16x16x32_bf16 v[184:187], v[208:211], v[120:123], v[184:187]
    v_mfma_f32_16x16x32_bf16 v[188:191], v[208:211], v[136:139], v[188:191]
    v_mfma_f32_16x16x32_bf16 v[192:195], v[208:211], v[152:155], v[192:195]
    s_waitcnt vmcnt(16)
    ds_read_b64_tr_b16 v[196:197], v244 offset:16384
    ds_read_b64_tr_b16 v[200:201], v245 offset:16384
    ds_read_b64_tr_b16 v[212:213], v246 offset:16384
    ds_read_b64_tr_b16 v[216:217], v247 offset:16384
    ds_read_b64_tr_b16 v[220:221], v248 offset:16384
    ds_read_b64_tr_b16 v[224:225], v249 offset:16384
    ds_read_b64_tr_b16 v[228:229], v250 offset:16384
    ds_read_b64_tr_b16 v[232:233], v251 offset:16384
    v_max3_f32 v252, v172, v173, v174
    v_max3_f32 v253, v175, v176, v177
    v_max3_f32 v252, v252, v178, v179
    v_max3_f32 v253, v253, v180, v181
    v_max3_f32 v252, v252, v182, v183
    v_max3_f32 v253, v253, v184, v185
    v_max3_f32 v252, v252, v186, v187
    v_max3_f32 v253, v253, v188, v189
    v_max3_f32 v252, v252, v190, v191
    v_max3_f32 v253, v253, v192, v193
    v_max3_f32 v252, v252, v194, v195
    v_max_f32 v252, v252, v253
    v_cmp_lt_f32 vcc, s53, v252
    s_cbranch_vccnz K1_RARE3
K1_BACK3:
    v_exp_f32 v172, v172
    v_exp_f32 v173, v173
    v_exp_f32 v174, v174
    v_exp_f32 v175, v175
    v_exp_f32 v184, v184
    v_exp_f32 v185, v185
    v_exp_f32 v186, v186
    v_exp_f32 v187, v187
    v_cvt_pk_bf16_f32 v172, v172, v173
    v_cvt_pk_bf16_f32 v173, v174, v175
    v_cvt_pk_bf16_f32 v174, v184, v185
    v_cvt_pk_bf16_f32 v175, v186, v187
    s_waitcnt lgkmcnt(0)
    s_add_u32 m0, s42, 16384
    s_mov_b32 s51, 36864
    buffer_load_dwordx4 v236, s[16:19], s51 offen offset:0 lds
    buffer_load_dwordx4 v237, s[16:19], s51 offen offset:1024 lds
    buffer_load_dwordx4 v238, s[16:19], s51 offen offset:2048 lds
    buffer_load_dwordx4 v239, s[16:19], s51 offen offset:3072 lds
    s_waitcnt vmcnt(16)
    ds_read_b64_tr_b16 v[198:199], v244 offset:0
    ds_read_b64_tr_b16 v[202:203], v245 offset:0
    ds_read_b64_tr_b16 v[214:215], v246 offset:0
    ds_read_b64_tr_b16 v[218:219], v247 offset:0
    ds_read_b64_tr_b16 v[222:223], v248 offset:0
    ds_read_b64_tr_b16 v[226:227], v249 offset:0
    ds_read_b64_tr_b16 v[230:231], v250 offset:0
    ds_read_b64_tr_b16 v[234:235], v251 offset:0
    v_exp_f32 v176, v176
    v_exp_f32 v177, v177
    v_exp_f32 v178, v178
    v_exp_f32 v179, v179
    v_exp_f32 v188, v188
    v_exp_f32 v189, v189
    v_exp_f32 v190, v190
    v_exp_f32 v191, v191
    v_cvt_pk_bf16_f32 v176, v176, v177
    v_cvt_pk_bf16_f32 v177, v178, v179
    v_cvt_pk_bf16_f32 v178, v188, v189
    v_cvt_pk_bf16_f32 v179, v190, v191
    v_exp_f32 v180, v180
    v_exp_f32 v181, v181
    v_exp_f32 v182, v182
    v_exp_f32 v183, v183
    v_exp_f32 v192, v192
    v_exp_f32 v193, v193
    v_exp_f32 v194, v194
    v_exp_f32 v195, v195
    v_cvt_pk_bf16_f32 v180, v180, v181
    v_cvt_pk_bf16_f32 v181, v182, v183
    v_cvt_pk_bf16_f32 v182, v192, v193
    v_cvt_pk_bf16_f32 v183, v194, v195
    v_mfma_f32_16x16x32_bf16 v[96:99], v[168:171], v[172:175], v[96:99]
    v_mfma_f32_16x16x32_bf16 v[100:103], v[168:171], v[176:179], v[100:103]
    v_mfma_f32_16x16x32_bf16 v[104:107], v[168:171], v[180:183], v[104:107]
    s_waitcnt lgkmcnt(0)
    s_add_u32 m0, s42, 0
    s_mov_b32 s51, 40960
    buffer_load_dwordx4 v236, s[12:15], s51 offen offset:0 lds
    buffer_load_dwordx4 v237, s[12:15], s51 offen offset:1024 lds
    buffer_load_dwordx4 v238, s[12:15], s51 offen offset:2048 lds
    buffer_load_dwordx4 v239, s[12:15], s51 offen offset:3072 lds
    v_mfma_f32_16x16x32_bf16 v[0:3], v[196:199], v[172:175], v[0:3]
    v_mfma_f32_16x16x32_bf16 v[4:7], v[196:199], v[176:179], v[4:7]
    v_mfma_f32_16x16x32_bf16 v[8:11], v[196:199], v[180:183], v[8:11]
    v_mfma_f32_16x16x32_bf16 v[12:15], v[200:203], v[172:175], v[12:15]
    v_mfma_f32_16x16x32_bf16 v[16:19], v[200:203], v[176:179], v[16:19]
    v_mfma_f32_16x16x32_bf16 v[20:23], v[200:203], v[180:183], v[20:23]
    v_mfma_f32_16x16x32_bf16 v[24:27], v[212:215], v[172:175], v[24:27]
    v_mfma_f32_16x16x32_bf16 v[28:31], v[212:215], v[176:179], v[28:31]
    v_mfma_f32_16x16x32_bf16 v[32:35], v[212:215], v[180:183], v[32:35]
    v_mfma_f32_16x16x32_bf16 v[36:39], v[216:219], v[172:175], v[36:39]
    v_mfma_f32_16x16x32_bf16 v[40:43], v[216:219], v[176:179], v[40:43]
    v_mfma_f32_16x16x32_bf16 v[44:47], v[216:219], v[180:183], v[44:47]
    s_waitcnt vmcnt(16)
    ds_read_b128 v[196:199], v240 offset:4096
    ds_read_b128 v[200:203], v241 offset:4096
    ds_read_b128 v[204:207], v242 offset:4096
    ds_read_b128 v[208:211], v243 offset:4096
    v_mfma_f32_16x16x32_bf16 v[48:51], v[220:223], v[172:175], v[48:51]
    v_mfma_f32_16x16x32_bf16 v[52:55], v[220:223], v[176:179], v[52:55]
    v_mfma_f32_16x16x32_bf16 v[56:59], v[220:223], v[180:183], v[56:59]
    v_mfma_f32_16x16x32_bf16 v[60:63], v[224:227], v[172:175], v[60:63]
    v_mfma_f32_16x16x32_bf16 v[64:67], v[224:227], v[176:179], v[64:67]
    v_mfma_f32_16x16x32_bf16 v[68:71], v[224:227], v[180:183], v[68:71]
    v_mfma_f32_16x16x32_bf16 v[72:75], v[228:231], v[172:175], v[72:75]
    v_mfma_f32_16x16x32_bf16 v[76:79], v[228:231], v[176:179], v[76:79]
    v_mfma_f32_16x16x32_bf16 v[80:83], v[228:231], v[180:183], v[80:83]
    s_waitcnt lgkmcnt(0)
    s_add_u32 m0, s42, 4096
    s_mov_b32 s51, 45056
    buffer_load_dwordx4 v236, s[12:15], s51 offen offset:0 lds
    buffer_load_dwordx4 v237, s[12:15], s51 offen offset:1024 lds
    buffer_load_dwordx4 v238, s[12:15], s51 offen offset:2048 lds
    buffer_load_dwordx4 v239, s[12:15], s51 offen offset:3072 lds
    v_mfma_f32_16x16x32_bf16 v[84:87], v[232:235], v[172:175], v[84:87]
    v_mfma_f32_16x16x32_bf16 v[88:91], v[232:235], v[176:179], v[88:91]
    v_mfma_f32_16x16x32_bf16 v[92:95], v[232:235], v[180:183], v[92:95]
    v_mfma_f32_16x16x32_bf16 v[172:175], v[196:199], v[108:111], v[156:159]
    v_mfma_f32_16x16x32_bf16 v[176:179], v[196:199], v[124:127], v[160:163]
    v_mfma_f32_16x16x32_bf16 v[180:183], v[196:199], v[140:143], v[164:167]
    s_waitcnt vmcnt(16)
    ds_read_b128 v[196:199], v240 offset:8192
    v_mfma_f32_16x16x32_bf16 v[172:175], v[200:203], v[112:115], v[172:175]
    v_mfma_f32_16x16x32_bf16 v[176:179], v[200:203], v[128:131], v[176:179]
    v_mfma_f32_16x16x32_bf16 v[180:183], v[200:203], v[144:147], v[180:183]
    ds_read_b128 v[200:203], v241 offset:8192
    v_mfma_f32_16x16x32_bf16 v[172:175], v[204:207], v[116:119], v[172:175]
    v_mfma_f32_16x16x32_bf16 v[176:179], v[204:207], v[132:135], v[176:179]
    v_mfma_f32_16x16x32_bf16 v[180:183], v[204:207], v[148:151], v[180:183]
    ds_read_b128 v[204:207], v242 offset:8192
    v_mfma_f32_16x16x32_bf16 v[172:175], v[208:211], v[120:123], v[172:175]
    v_mfma_f32_16x16x32_bf16 v[176:179], v[208:211], v[136:139], v[176:179]
    v_mfma_f32_16x16x32_bf16 v[180:183], v[208:211], v[152:155], v[180:183]
    ds_read_b128 v[208:211], v243 offset:8192
    s_waitcnt lgkmcnt(3)
    v_mfma_f32_16x16x32_bf16 v[184:187], v[196:199], v[108:111], v[156:159]
    v_mfma_f32_16x16x32_bf16 v[188:191], v[196:199], v[124:127], v[160:163]
    v_mfma_f32_16x16x32_bf16 v[192:195], v[196:199], v[140:143], v[164:167]
    s_waitcnt lgkmcnt(2)
    v_mfma_f32_16x16x32_bf16 v[184:187], v[200:203], v[112:115], v[184:187]
    v_mfma_f32_16x16x32_bf16 v[188:191], v[200:203], v[128:131], v[188:191]
    v_mfma_f32_16x16x32_bf16 v[192:195], v[200:203], v[144:147], v[192:195]
    s_waitcnt lgkmcnt(1)
    v_mfma_f32_16x16x32_bf16 v[184:187], v[204:207], v[116:119], v[184:187]
    v_mfma_f32_16x16x32_bf16 v[188:191], v[204:207], v[132:135], v[188:191]
    v_mfma_f32_16x16x32_bf16 v[192:195], v[204:207], v[148:151], v[192:195]
    s_waitcnt lgkmcnt(0)
    s_add_u32 m0, s42, 8192
    s_mov_b32 s51, 40960
    buffer_load_dwordx4 v236, s[16:19], s51 offen offset:0 lds
    buffer_load_dwordx4 v237, s[16:19], s51 offen offset:1024 lds
    buffer_load_dwordx4 v238, s[16:19], s51 offen offset:2048 lds
    buffer_load_dwordx4 v239, s[16:19], s51 offen offset:3072 lds
    v_mfma_f32_16x16x32_bf16 v[184:187], v[208:211], v[120:123], v[184:187]
    v_mfma_f32_16x16x32_bf16 v[188:191], v[208:211], v[136:139], v[188:191]
    v_mfma_f32_16x16x32_bf16 v[192:195], v[208:211], v[152:155], v[192:195]
    s_waitcnt vmcnt(16)
    ds_read_b64_tr_b16 v[196:197], v244 offset:12288
    ds_read_b64_tr_b16 v[200:201], v245 offset:12288
    ds_read_b64_tr_b16 v[212:213], v246 offset:12288
    ds_read_b64_tr_b16 v[216:217], v247 offset:12288
    ds_read_b64_tr_b16 v[220:221], v248 offset:12288
    ds_read_b64_tr_b16 v[224:225], v249 offset:12288
    ds_read_b64_tr_b16 v[228:229], v250 offset:12288
    ds_read_b64_tr_b16 v[232:233], v251 offset:12288
    v_max3_f32 v252, v172, v173, v174
    v_max3_f32 v253, v175, v176, v177
    v_max3_f32 v252, v252, v178, v179
    v_max3_f32 v253, v253, v180, v181
    v_max3_f32 v252, v252, v182, v183
    v_max3_f32 v253, v253, v184, v185
    v_max3_f32 v252, v252, v186, v187
    v_max3_f32 v253, v253, v188, v189
    v_max3_f32 v252, v252, v190, v191
    v_max3_f32 v253, v253, v192, v193
    v_max3_f32 v252, v252, v194, v195
    v_max_f32 v252, v252, v253
    v_cmp_lt_f32 vcc, s53, v252
    s_cbranch_vccnz K1_RARE4
K1_BACK4:
    v_exp_f32 v172, v172
    v_exp_f32 v173, v173
    v_exp_f32 v174, v174
    v_exp_f32 v175, v175
    v_exp_f32 v184, v184
    v_exp_f32 v185, v185
    v_exp_f32 v186, v186
    v_exp_f32 v187, v187
    v_cvt_pk_bf16_f32 v172, v172, v173
    v_cvt_pk_bf16_f32 v173, v174, v175
    v_cvt_pk_bf16_f32 v174, v184, v185
    v_cvt_pk_bf16_f32 v175, v186, v187
    s_waitcnt lgkmcnt(0)
    s_add_u32 m0, s42, 12288
    s_mov_b32 s51, 45056
    buffer_load_dwordx4 v236, s[16:19], s51 offen offset:0 lds
    buffer_load_dwordx4 v237, s[16:19], s51 offen offset:1024 lds
    buffer_load_dwordx4 v238, s[16:19], s51 offen offset:2048 lds
    buffer_load_dwordx4 v239, s[16:19], s51 offen offset:3072 lds
    s_waitcnt vmcnt(16)
    ds_read_b64_tr_b16 v[198:199], v244 offset:16384
    ds_read_b64_tr_b16 v[202:203], v245 offset:16384
    ds_read_b64_tr_b16 v[214:215], v246 offset:16384
    ds_read_b64_tr_b16 v[218:219], v247 offset:16384
    ds_read_b64_tr_b16 v[222:223], v248 offset:16384
    ds_read_b64_tr_b16 v[226:227], v249 offset:16384
    ds_read_b64_tr_b16 v[230:231], v250 offset:16384
    ds_read_b64_tr_b16 v[234:235], v251 offset:16384
    v_exp_f32 v176, v176
    v_exp_f32 v177, v177
    v_exp_f32 v178, v178
    v_exp_f32 v179, v179
    v_exp_f32 v188, v188
    v_exp_f32 v189, v189
    v_exp_f32 v190, v190
    v_exp_f32 v191, v191
    v_cvt_pk_bf16_f32 v176, v176, v177
    v_cvt_pk_bf16_f32 v177, v178, v179
    v_cvt_pk_bf16_f32 v178, v188, v189
    v_cvt_pk_bf16_f32 v179, v190, v191
    v_exp_f32 v180, v180
    v_exp_f32 v181, v181
    v_exp_f32 v182, v182
    v_exp_f32 v183, v183
    v_exp_f32 v192, v192
    v_exp_f32 v193, v193
    v_exp_f32 v194, v194
    v_exp_f32 v195, v195
    v_cvt_pk_bf16_f32 v180, v180, v181
    v_cvt_pk_bf16_f32 v181, v182, v183
    v_cvt_pk_bf16_f32 v182, v192, v193
    v_cvt_pk_bf16_f32 v183, v194, v195
    v_mfma_f32_16x16x32_bf16 v[96:99], v[168:171], v[172:175], v[96:99]
    v_mfma_f32_16x16x32_bf16 v[100:103], v[168:171], v[176:179], v[100:103]
    v_mfma_f32_16x16x32_bf16 v[104:107], v[168:171], v[180:183], v[104:107]
    s_waitcnt lgkmcnt(0)
    s_add_u32 m0, s42, 16384
    s_mov_b32 s51, 49152
    buffer_load_dwordx4 v236, s[12:15], s51 offen offset:0 lds
    buffer_load_dwordx4 v237, s[12:15], s51 offen offset:1024 lds
    buffer_load_dwordx4 v238, s[12:15], s51 offen offset:2048 lds
    buffer_load_dwordx4 v239, s[12:15], s51 offen offset:3072 lds
    v_mfma_f32_16x16x32_bf16 v[0:3], v[196:199], v[172:175], v[0:3]
    v_mfma_f32_16x16x32_bf16 v[4:7], v[196:199], v[176:179], v[4:7]
    v_mfma_f32_16x16x32_bf16 v[8:11], v[196:199], v[180:183], v[8:11]
    v_mfma_f32_16x16x32_bf16 v[12:15], v[200:203], v[172:175], v[12:15]
    v_mfma_f32_16x16x32_bf16 v[16:19], v[200:203], v[176:179], v[16:19]
    v_mfma_f32_16x16x32_bf16 v[20:23], v[200:203], v[180:183], v[20:23]
    v_mfma_f32_16x16x32_bf16 v[24:27], v[212:215], v[172:175], v[24:27]
    v_mfma_f32_16x16x32_bf16 v[28:31], v[212:215], v[176:179], v[28:31]
    v_mfma_f32_16x16x32_bf16 v[32:35], v[212:215], v[180:183], v[32:35]
    v_mfma_f32_16x16x32_bf16 v[36:39], v[216:219], v[172:175], v[36:39]
    v_mfma_f32_16x16x32_bf16 v[40:43], v[216:219], v[176:179], v[40:43]
    v_mfma_f32_16x16x32_bf16 v[44:47], v[216:219], v[180:183], v[44:47]
    s_waitcnt vmcnt(16)
    ds_read_b128 v[196:199], v240 offset:0
    ds_read_b128 v[200:203], v241 offset:0
    ds_read_b128 v[204:207], v242 offset:0
    ds_read_b128 v[208:211], v243 offset:0
    v_mfma_f32_16x16x32_bf16 v[48:51], v[220:223], v[172:175], v[48:51]
    v_mfma_f32_16x16x32_bf16 v[52:55], v[220:223], v[176:179], v[52:55]
    v_mfma_f32_16x16x32_bf16 v[56:59], v[220:223], v[180:183], v[56:59]
    v_mfma_f32_16x16x32_bf16 v[60:63], v[224:227], v[172:175], v[60:63]
    v_mfma_f32_16x16x32_bf16 v[64:67], v[224:227], v[176:179], v[64:67]
    v_mfma_f32_16x16x32_bf16 v[68:71], v[224:227], v[180:183], v[68:71]
    v_mfma_f32_16x16x32_bf16 v[72:75], v[228:231], v[172:175], v[72:75]
    v_mfma_f32_16x16x32_bf16 v[76:79], v[228:231], v[176:179], v[76:79]
    v_mfma_f32_16x16x32_bf16 v[80:83], v[228:231], v[180:183], v[80:83]
    s_waitcnt lgkmcnt(0)
    s_add_u32 m0, s42, 0
    s_mov_b32 s51, 53248
    buffer_load_dwordx4 v236, s[12:15], s51 offen offset:0 lds
    buffer_load_dwordx4 v237, s[12:15], s51 offen offset:1024 lds
    buffer_load_dwordx4 v238, s[12:15], s51 offen offset:2048 lds
    buffer_load_dwordx4 v239, s[12:15], s51 offen offset:3072 lds
    v_mfma_f32_16x16x32_bf16 v[84:87], v[232:235], v[172:175], v[84:87]
    v_mfma_f32_16x16x32_bf16 v[88:91], v[232:235], v[176:179], v[88:91]
    v_mfma_f32_16x16x32_bf16 v[92:95], v[232:235], v[180:183], v[92:95]
    v_mfma_f32_16x16x32_bf16 v[172:175], v[196:199], v[108:111], v[156:159]
    v_mfma_f32_16x16x32_bf16 v[176:179], v[196:199], v[124:127], v[160:163]
    v_mfma_f32_16x16x32_bf16 v[180:183], v[196:199], v[140:143], v[164:167]
    s_waitcnt vmcnt(16)
    ds_read_b128 v[196:199], v240 offset:4096
    v_mfma_f32_16x16x32_bf16 v[172:175], v[200:203], v[112:115], v[172:175]
    v_mfma_f32_16x16x32_bf16 v[176:179], v[200:203], v[128:131], v[176:179]
    v_mfma_f32_16x16x32_bf16 v[180:183], v[200:203], v[144:147], v[180:183]
    ds_read_b128 v[200:203], v241 offset:4096
    v_mfma_f32_16x16x32_bf16 v[172:175], v[204:207], v[116:119], v[172:175]
    v_mfma_f32_16x16x32_bf16 v[176:179], v[204:207], v[132:135], v[176:179]
    v_mfma_f32_16x16x32_bf16 v[180:183], v[204:207], v[148:151], v[180:183]
    ds_read_b128 v[204:207], v242 offset:4096
    v_mfma_f32_16x16x32_bf16 v[172:175], v[208:211], v[120:123], v[172:175]
    v_mfma_f32_16x16x32_bf16 v[176:179], v[208:211], v[136:139], v[176:179]
    v_mfma_f32_16x16x32_bf16 v[180:183], v[208:211], v[152:155], v[180:183]
    ds_read_b128 v[208:211], v243 offset:4096
    s_waitcnt lgkmcnt(3)
    v_mfma_f32_16x16x32_bf16 v[184:187], v[196:199], v[108:111], v[156:159]
    v_mfma_f32_16x16x32_bf16 v[188:191], v[196:199], v[124:127], v[160:163]
    v_mfma_f32_16x16x32_bf16 v[192:195], v[196:199], v[140:143], v[164:167]
    s_waitcnt lgkmcnt(2)
    v_mfma_f32_16x16x32_bf16 v[184:187], v[200:203], v[112:115], v[184:187]
    v_mfma_f32_16x16x32_bf16 v[188:191], v[200:203], v[128:131], v[188:191]
    v_mfma_f32_16x16x32_bf16 v[192:195], v[200:203], v[144:147], v[192:195]
    s_waitcnt lgkmcnt(1)
    v_mfma_f32_16x16x32_bf16 v[184:187], v[204:207], v[116:119], v[184:187]
    v_mfma_f32_16x16x32_bf16 v[188:191], v[204:207], v[132:135], v[188:191]
    v_mfma_f32_16x16x32_bf16 v[192:195], v[204:207], v[148:151], v[192:195]
    s_waitcnt lgkmcnt(0)
    s_add_u32 m0, s42, 4096
    s_mov_b32 s51, 49152
    buffer_load_dwordx4 v236, s[16:19], s51 offen offset:0 lds
    buffer_load_dwordx4 v237, s[16:19], s51 offen offset:1024 lds
    buffer_load_dwordx4 v238, s[16:19], s51 offen offset:2048 lds
    buffer_load_dwordx4 v239, s[16:19], s51 offen offset:3072 lds
    v_mfma_f32_16x16x32_bf16 v[184:187], v[208:211], v[120:123], v[184:187]
    v_mfma_f32_16x16x32_bf16 v[188:191], v[208:211], v[136:139], v[188:191]
    v_mfma_f32_16x16x32_bf16 v[192:195], v[208:211], v[152:155], v[192:195]
    s_waitcnt vmcnt(16)
    ds_read_b64_tr_b16 v[196:197], v244 offset:8192
    ds_read_b64_tr_b16 v[200:201], v245 offset:8192
    ds_read_b64_tr_b16 v[212:213], v246 offset:8192
    ds_read_b64_tr_b16 v[216:217], v247 offset:8192
    ds_read_b64_tr_b16 v[220:221], v248 offset:8192
    ds_read_b64_tr_b16 v[224:225], v249 offset:8192
    ds_read_b64_tr_b16 v[228:229], v250 offset:8192
    ds_read_b64_tr_b16 v[232:233], v251 offset:8192
    v_max3_f32 v252, v172, v173, v174
    v_max3_f32 v253, v175, v176, v177
    v_max3_f32 v252, v252, v178, v179
    v_max3_f32 v253, v253, v180, v181
    v_max3_f32 v252, v252, v182, v183
    v_max3_f32 v253, v253, v184, v185
    v_max3_f32 v252, v252, v186, v187
    v_max3_f32 v253, v253, v188, v189
    v_max3_f32 v252, v252, v190, v191
    v_max3_f32 v253, v253, v192, v193
    v_max3_f32 v252, v252, v194, v195
    v_max_f32 v252, v252, v253
    v_cmp_lt_f32 vcc, s53, v252
    s_cbranch_vccnz K1_RARE5
K1_BACK5:
    v_exp_f32 v172, v172
    v_exp_f32 v173, v173
    v_exp_f32 v174, v174
    v_exp_f32 v175, v175
    v_exp_f32 v184, v184
    v_exp_f32 v185, v185
    v_exp_f32 v186, v186
    v_exp_f32 v187, v187
    v_cvt_pk_bf16_f32 v172, v172, v173
    v_cvt_pk_bf16_f32 v173, v174, v175
    v_cvt_pk_bf16_f32 v174, v184, v185
    v_cvt_pk_bf16_f32 v175, v186, v187
    s_waitcnt lgkmcnt(0)
    s_add_u32 m0, s42, 8192
    s_mov_b32 s51, 53248
    buffer_load_dwordx4 v236, s[16:19], s51 offen offset:0 lds
    buffer_load_dwordx4 v237, s[16:19], s51 offen offset:1024 lds
    buffer_load_dwordx4 v238, s[16:19], s51 offen offset:2048 lds
    buffer_load_dwordx4 v239, s[16:19], s51 offen offset:3072 lds
    s_waitcnt vmcnt(16)
    ds_read_b64_tr_b16 v[198:199], v244 offset:12288
    ds_read_b64_tr_b16 v[202:203], v245 offset:12288
    ds_read_b64_tr_b16 v[214:215], v246 offset:12288
    ds_read_b64_tr_b16 v[218:219], v247 offset:12288
    ds_read_b64_tr_b16 v[222:223], v248 offset:12288
    ds_read_b64_tr_b16 v[226:227], v249 offset:12288
    ds_read_b64_tr_b16 v[230:231], v250 offset:12288
    ds_read_b64_tr_b16 v[234:235], v251 offset:12288
    v_exp_f32 v176, v176
    v_exp_f32 v177, v177
    v_exp_f32 v178, v178
    v_exp_f32 v179, v179
    v_exp_f32 v188, v188
    v_exp_f32 v189, v189
    v_exp_f32 v190, v190
    v_exp_f32 v191, v191
    v_cvt_pk_bf16_f32 v176, v176, v177
    v_cvt_pk_bf16_f32 v177, v178, v179
    v_cvt_pk_bf16_f32 v178, v188, v189
    v_cvt_pk_bf16_f32 v179, v190, v191
    v_exp_f32 v180, v180
    v_exp_f32 v181, v181
    v_exp_f32 v182, v182
    v_exp_f32 v183, v183
    v_exp_f32 v192, v192
    v_exp_f32 v193, v193
    v_exp_f32 v194, v194
    v_exp_f32 v195, v195
    v_cvt_pk_bf16_f32 v180, v180, v181
    v_cvt_pk_bf16_f32 v181, v182, v183
    v_cvt_pk_bf16_f32 v182, v192, v193
    v_cvt_pk_bf16_f32 v183, v194, v195
    v_mfma_f32_16x16x32_bf16 v[96:99], v[168:171], v[172:175], v[96:99]
    v_mfma_f32_16x16x32_bf16 v[100:103], v[168:171], v[176:179], v[100:103]
    v_mfma_f32_16x16x32_bf16 v[104:107], v[168:171], v[180:183], v[104:107]
    s_waitcnt lgkmcnt(0)
    s_add_u32 m0, s42, 12288
    s_mov_b32 s51, 57344
    buffer_load_dwordx4 v236, s[12:15], s51 offen offset:0 lds
    buffer_load_dwordx4 v237, s[12:15], s51 offen offset:1024 lds
    buffer_load_dwordx4 v238, s[12:15], s51 offen offset:2048 lds
    buffer_load_dwordx4 v239, s[12:15], s51 offen offset:3072 lds
    v_mfma_f32_16x16x32_bf16 v[0:3], v[196:199], v[172:175], v[0:3]
    v_mfma_f32_16x16x32_bf16 v[4:7], v[196:199], v[176:179], v[4:7]
    v_mfma_f32_16x16x32_bf16 v[8:11], v[196:199], v[180:183], v[8:11]
    v_mfma_f32_16x16x32_bf16 v[12:15], v[200:203], v[172:175], v[12:15]
    v_mfma_f32_16x16x32_bf16 v[16:19], v[200:203], v[176:179], v[16:19]
    v_mfma_f32_16x16x32_bf16 v[20:23], v[200:203], v[180:183], v[20:23]
    v_mfma_f32_16x16x32_bf16 v[24:27], v[212:215], v[172:175], v[24:27]
    v_mfma_f32_16x16x32_bf16 v[28:31], v[212:215], v[176:179], v[28:31]
    v_mfma_f32_16x16x32_bf16 v[32:35], v[212:215], v[180:183], v[32:35]
    v_mfma_f32_16x16x32_bf16 v[36:39], v[216:219], v[172:175], v[36:39]
    v_mfma_f32_16x16x32_bf16 v[40:43], v[216:219], v[176:179], v[40:43]
    v_mfma_f32_16x16x32_bf16 v[44:47], v[216:219], v[180:183], v[44:47]
    s_waitcnt vmcnt(16)
    ds_read_b128 v[196:199], v240 offset:16384
    ds_read_b128 v[200:203], v241 offset:16384
    ds_read_b128 v[204:207], v242 offset:16384
    ds_read_b128 v[208:211], v243 offset:16384
    v_mfma_f32_16x16x32_bf16 v[48:51], v[220:223], v[172:175], v[48:51]
    v_mfma_f32_16x16x32_bf16 v[52:55], v[220:223], v[176:179], v[52:55]
    v_mfma_f32_16x16x32_bf16 v[56:59], v[220:223], v[180:183], v[56:59]
    v_mfma_f32_16x16x32_bf16 v[60:63], v[224:227], v[172:175], v[60:63]
    v_mfma_f32_16x16x32_bf16 v[64:67], v[224:227], v[176:179], v[64:67]
    v_mfma_f32_16x16x32_bf16 v[68:71], v[224:227], v[180:183], v[68:71]
    v_mfma_f32_16x16x32_bf16 v[72:75], v[228:231], v[172:175], v[72:75]
    v_mfma_f32_16x16x32_bf16 v[76:79], v[228:231], v[176:179], v[76:79]
    v_mfma_f32_16x16x32_bf16 v[80:83], v[228:231], v[180:183], v[80:83]
    s_waitcnt lgkmcnt(0)
    s_add_u32 m0, s42, 16384
    s_mov_b32 s51, 61440
    buffer_load_dwordx4 v236, s[12:15], s51 offen offset:0 lds
    buffer_load_dwordx4 v237, s[12:15], s51 offen offset:1024 lds
    buffer_load_dwordx4 v238, s[12:15], s51 offen offset:2048 lds
    buffer_load_dwordx4 v239, s[12:15], s51 offen offset:3072 lds
    v_mfma_f32_16x16x32_bf16 v[84:87], v[232:235], v[172:175], v[84:87]
    v_mfma_f32_16x16x32_bf16 v[88:91], v[232:235], v[176:179], v[88:91]
    v_mfma_f32_16x16x32_bf16 v[92:95], v[232:235], v[180:183], v[92:95]
    v_mfma_f32_16x16x32_bf16 v[172:175], v[196:199], v[108:111], v[156:159]
    v_mfma_f32_16x16x32_bf16 v[176:179], v[196:199], v[124:127], v[160:163]
    v_mfma_f32_16x16x32_bf16 v[180:183], v[196:199], v[140:143], v[164:167]
    s_waitcnt vmcnt(16)
    ds_read_b128 v[196:199], v240 offset:0
    v_mfma_f32_16x16x32_bf16 v[172:175], v[200:203], v[112:115], v[172:175]
    v_mfma_f32_16x16x32_bf16 v[176:179], v[200:203], v[128:131], v[176:179]
    v_mfma_f32_16x16x32_bf16 v[180:183], v[200:203], v[144:147], v[180:183]
    ds_read_b128 v[200:203], v241 offset:0
    v_mfma_f32_16x16x32_bf16 v[172:175], v[204:207], v[116:119], v[172:175]
    v_mfma_f32_16x16x32_bf16 v[176:179], v[204:207], v[132:135], v[176:179]
    v_mfma_f32_16x16x32_bf16 v[180:183], v[204:207], v[148:151], v[180:183]
    ds_read_b128 v[204:207], v242 offset:0
    v_mfma_f32_16x16x32_bf16 v[172:175], v[208:211], v[120:123], v[172:175]
    v_mfma_f32_16x16x32_bf16 v[176:179], v[208:211], v[136:139], v[176:179]
    v_mfma_f32_16x16x32_bf16 v[180:183], v[208:211], v[152:155], v[180:183]
    ds_read_b128 v[208:211], v243 offset:0
    s_waitcnt lgkmcnt(3)
    v_mfma_f32_16x16x32_bf16 v[184:187], v[196:199], v[108:111], v[156:159]
    v_mfma_f32_16x16x32_bf16 v[188:191], v[196:199], v[124:127], v[160:163]
    v_mfma_f32_16x16x32_bf16 v[192:195], v[196:199], v[140:143], v[164:167]
    s_waitcnt lgkmcnt(2)
    v_mfma_f32_16x16x32_bf16 v[184:187], v[200:203], v[112:115], v[184:187]
    v_mfma_f32_16x16x32_bf16 v[188:191], v[200:203], v[128:131], v[188:191]
    v_mfma_f32_16x16x32_bf16 v[192:195], v[200:203], v[144:147], v[192:195]
    s_waitcnt lgkmcnt(1)
    v_mfma_f32_16x16x32_bf16 v[184:187], v[204:207], v[116:119], v[184:187]
    v_mfma_f32_16x16x32_bf16 v[188:191], v[204:207], v[132:135], v[188:191]
    v_mfma_f32_16x16x32_bf16 v[192:195], v[204:207], v[148:151], v[192:195]
    s_waitcnt lgkmcnt(0)
    s_add_u32 m0, s42, 0
    s_mov_b32 s51, 0
    buffer_load_dwordx4 v255, s[24:27], s51 offen nt lds
    s_add_u32 m0, s42, 1024
    s_mov_b32 s51, 16384
    buffer_load_dwordx4 v255, s[24:27], s51 offen nt lds
    s_add_u32 m0, s42, 2048
    s_mov_b32 s51, 32768
    buffer_load_dwordx4 v255, s[24:27], s51 offen nt lds
    s_add_u32 m0, s42, 3072
    s_mov_b32 s51, 49152
    buffer_load_dwordx4 v255, s[24:27], s51 offen nt lds
    v_mfma_f32_16x16x32_bf16 v[184:187], v[208:211], v[120:123], v[184:187]
    v_mfma_f32_16x16x32_bf16 v[188:191], v[208:211], v[136:139], v[188:191]
    v_mfma_f32_16x16x32_bf16 v[192:195], v[208:211], v[152:155], v[192:195]
    s_waitcnt vmcnt(16)
    ds_read_b64_tr_b16 v[196:197], v244 offset:4096
    ds_read_b64_tr_b16 v[200:201], v245 offset:4096
    ds_read_b64_tr_b16 v[212:213], v246 offset:4096
    ds_read_b64_tr_b16 v[216:217], v247 offset:4096
    ds_read_b64_tr_b16 v[220:221], v248 offset:4096
    ds_read_b64_tr_b16 v[224:225], v249 offset:4096
    ds_read_b64_tr_b16 v[228:229], v250 offset:4096
    ds_read_b64_tr_b16 v[232:233], v251 offset:4096
    v_max3_f32 v252, v172, v173, v174
    v_max3_f32 v253, v175, v176, v177
    v_max3_f32 v252, v252, v178, v179
    v_max3_f32 v253, v253, v180, v181
    v_max3_f32 v252, v252, v182, v183
    v_max3_f32 v253, v253, v184, v185
    v_max3_f32 v252, v252, v186, v187
    v_max3_f32 v253, v253, v188, v189
    v_max3_f32 v252, v252, v190, v191
    v_max3_f32 v253, v253, v192, v193
    v_max3_f32 v252, v252, v194, v195
    v_max_f32 v252, v252, v253
    v_cmp_lt_f32 vcc, s53, v252
    s_cbranch_vccnz K1_RARE6
K1_BACK6:
    v_exp_f32 v172, v172
    v_exp_f32 v173, v173
    v_exp_f32 v174, v174
    v_exp_f32 v175, v175
    v_exp_f32 v184, v184
    v_exp_f32 v185, v185
    v_exp_f32 v186, v186
    v_exp_f32 v187, v187
    v_cvt_pk_bf16_f32 v172, v172, v173
    v_cvt_pk_bf16_f32 v173, v174, v175
    v_cvt_pk_bf16_f32 v174, v184, v185
    v_cvt_pk_bf16_f32 v175, v186, v187
    s_waitcnt lgkmcnt(0)
    s_add_u32 m0, s42, 4096
    s_mov_b32 s51, 57344
    buffer_load_dwordx4 v236, s[16:19], s51 offen offset:0 lds
    buffer_load_dwordx4 v237, s[16:19], s51 offen offset:1024 lds
    buffer_load_dwordx4 v238, s[16:19], s51 offen offset:2048 lds
    buffer_load_dwordx4 v239, s[16:19], s51 offen offset:3072 lds
    s_waitcnt vmcnt(16)
    ds_read_b64_tr_b16 v[198:199], v244 offset:8192
    ds_read_b64_tr_b16 v[202:203], v245 offset:8192
    ds_read_b64_tr_b16 v[214:215], v246 offset:8192
    ds_read_b64_tr_b16 v[218:219], v247 offset:8192
    ds_read_b64_tr_b16 v[222:223], v248 offset:8192
    ds_read_b64_tr_b16 v[226:227], v249 offset:8192
    ds_read_b64_tr_b16 v[230:231], v250 offset:8192
    ds_read_b64_tr_b16 v[234:235], v251 offset:8192
    v_exp_f32 v176, v176
    v_exp_f32 v177, v177
    v_exp_f32 v178, v178
    v_exp_f32 v179, v179
    v_exp_f32 v188, v188
    v_exp_f32 v189, v189
    v_exp_f32 v190, v190
    v_exp_f32 v191, v191
    v_cvt_pk_bf16_f32 v176, v176, v177
    v_cvt_pk_bf16_f32 v177, v178, v179
    v_cvt_pk_bf16_f32 v178, v188, v189
    v_cvt_pk_bf16_f32 v179, v190, v191
    v_exp_f32 v180, v180
    v_exp_f32 v181, v181
    v_exp_f32 v182, v182
    v_exp_f32 v183, v183
    v_exp_f32 v192, v192
    v_exp_f32 v193, v193
    v_exp_f32 v194, v194
    v_exp_f32 v195, v195
    v_cvt_pk_bf16_f32 v180, v180, v181
    v_cvt_pk_bf16_f32 v181, v182, v183
    v_cvt_pk_bf16_f32 v182, v192, v193
    v_cvt_pk_bf16_f32 v183, v194, v195
    v_mfma_f32_16x16x32_bf16 v[96:99], v[168:171], v[172:175], v[96:99]
    v_mfma_f32_16x16x32_bf16 v[100:103], v[168:171], v[176:179], v[100:103]
    v_mfma_f32_16x16x32_bf16 v[104:107], v[168:171], v[180:183], v[104:107]
    s_waitcnt lgkmcnt(0)
    s_add_u32 m0, s42, 8192
    s_mov_b32 s51, 61440
    buffer_load_dwordx4 v236, s[16:19], s51 offen offset:0 lds
    buffer_load_dwordx4 v237, s[16:19], s51 offen offset:1024 lds
    buffer_load_dwordx4 v238, s[16:19], s51 offen offset:2048 lds
    buffer_load_dwordx4 v239, s[16:19], s51 offen offset:3072 lds
    v_mfma_f32_16x16x32_bf16 v[0:3], v[196:199], v[172:175], v[0:3]
    v_mfma_f32_16x16x32_bf16 v[4:7], v[196:199], v[176:179], v[4:7]
    v_mfma_f32_16x16x32_bf16 v[8:11], v[196:199], v[180:183], v[8:11]
    v_mfma_f32_16x16x32_bf16 v[12:15], v[200:203], v[172:175], v[12:15]
    v_mfma_f32_16x16x32_bf16 v[16:19], v[200:203], v[176:179], v[16:19]
    v_mfma_f32_16x16x32_bf16 v[20:23], v[200:203], v[180:183], v[20:23]
    v_mfma_f32_16x16x32_bf16 v[24:27], v[212:215], v[172:175], v[24:27]
    v_mfma_f32_16x16x32_bf16 v[28:31], v[212:215], v[176:179], v[28:31]
    v_mfma_f32_16x16x32_bf16 v[32:35], v[212:215], v[180:183], v[32:35]
    v_mfma_f32_16x16x32_bf16 v[36:39], v[216:219], v[172:175], v[36:39]
    v_mfma_f32_16x16x32_bf16 v[40:43], v[216:219], v[176:179], v[40:43]
    v_mfma_f32_16x16x32_bf16 v[44:47], v[216:219], v[180:183], v[44:47]
    s_waitcnt vmcnt(16)
    ds_read_b128 v[196:199], v240 offset:12288
    ds_read_b128 v[200:203], v241 offset:12288
    ds_read_b128 v[204:207], v242 offset:12288
    ds_read_b128 v[208:211], v243 offset:12288
    v_mfma_f32_16x16x32_bf16 v[48:51], v[220:223], v[172:175], v[48:51]
    v_mfma_f32_16x16x32_bf16 v[52:55], v[220:223], v[176:179], v[52:55]
    v_mfma_f32_16x16x32_bf16 v[56:59], v[220:223], v[180:183], v[56:59]
    v_mfma_f32_16x16x32_bf16 v[60:63], v[224:227], v[172:175], v[60:63]
    v_mfma_f32_16x16x32_bf16 v[64:67], v[224:227], v[176:179], v[64:67]
    v_mfma_f32_16x16x32_bf16 v[68:71], v[224:227], v[180:183], v[68:71]
    v_mfma_f32_16x16x32_bf16 v[72:75], v[228:231], v[172:175], v[72:75]
    v_mfma_f32_16x16x32_bf16 v[76:79], v[228:231], v[176:179], v[76:79]
    v_mfma_f32_16x16x32_bf16 v[80:83], v[228:231], v[180:183], v[80:83]
    s_waitcnt lgkmcnt(0)
    v_mfma_f32_16x16x32_bf16 v[84:87], v[232:235], v[172:175], v[84:87]
    v_mfma_f32_16x16x32_bf16 v[88:91], v[232:235], v[176:179], v[88:91]
    v_mfma_f32_16x16x32_bf16 v[92:95], v[232:235], v[180:183], v[92:95]
    v_mfma_f32_16x16x32_bf16 v[172:175], v[196:199], v[108:111], v[156:159]
    v_mfma_f32_16x16x32_bf16 v[176:179], v[196:199], v[124:127], v[160:163]
    v_mfma_f32_16x16x32_bf16 v[180:183], v[196:199], v[140:143], v[164:167]
    s_waitcnt vmcnt(12)
    ds_read_b128 v[196:199], v240 offset:16384
    v_mfma_f32_16x16x32_bf16 v[172:175], v[200:203], v[112:115], v[172:175]
    v_mfma_f32_16x16x32_bf16 v[176:179], v[200:203], v[128:131], v[176:179]
    v_mfma_f32_16x16x32_bf16 v[180:183], v[200:203], v[144:147], v[180:183]
    ds_read_b128 v[200:203], v241 offset:16384
    v_mfma_f32_16x16x32_bf16 v[172:175], v[204:207], v[116:119], v[172:175]
    v_mfma_f32_16x16x32_bf16 v[176:179], v[204:207], v[132:135], v[176:179]
    v_mfma_f32_16x16x32_bf16 v[180:183], v[204:207], v[148:151], v[180:183]
    ds_read_b128 v[204:207], v242 offset:16384
    v_mfma_f32_16x16x32_bf16 v[172:175], v[208:211], v[120:123], v[172:175]
    v_mfma_f32_16x16x32_bf16 v[176:179], v[208:211], v[136:139], v[176:179]
    v_mfma_f32_16x16x32_bf16 v[180:183], v[208:211], v[152:155], v[180:183]
    ds_read_b128 v[208:211], v243 offset:16384
    s_waitcnt lgkmcnt(3)
    v_mfma_f32_16x16x32_bf16 v[184:187], v[196:199], v[108:111], v[156:159]
    v_mfma_f32_16x16x32_bf16 v[188:191], v[196:199], v[124:127], v[160:163]
    v_mfma_f32_16x16x32_bf16 v[192:195], v[196:199], v[140:143], v[164:167]
    s_waitcnt lgkmcnt(2)
    v_mfma_f32_16x16x32_bf16 v[184:187], v[200:203], v[112:115], v[184:187]
    v_mfma_f32_16x16x32_bf16 v[188:191], v[200:203], v[128:131], v[188:191]
    v_mfma_f32_16x16x32_bf16 v[192:195], v[200:203], v[144:147], v[192:195]
    s_waitcnt lgkmcnt(1)
    v_mfma_f32_16x16x32_bf16 v[184:187], v[204:207], v[116:119], v[184:187]
    v_mfma_f32_16x16x32_bf16 v[188:191], v[204:207], v[132:135], v[188:191]
    v_mfma_f32_16x16x32_bf16 v[192:195], v[204:207], v[148:151], v[192:195]
    s_waitcnt lgkmcnt(0)
    v_mfma_f32_16x16x32_bf16 v[184:187], v[208:211], v[120:123], v[184:187]
    v_mfma_f32_16x16x32_bf16 v[188:191], v[208:211], v[136:139], v[188:191]
    v_mfma_f32_16x16x32_bf16 v[192:195], v[208:211], v[152:155], v[192:195]
    s_waitcnt vmcnt(4)
    ds_read_b64_tr_b16 v[196:197], v244 offset:4096
    ds_read_b64_tr_b16 v[200:201], v245 offset:4096
    ds_read_b64_tr_b16 v[212:213], v246 offset:4096
    ds_read_b64_tr_b16 v[216:217], v247 offset:4096
    ds_read_b64_tr_b16 v[220:221], v248 offset:4096
    ds_read_b64_tr_b16 v[224:225], v249 offset:4096
    ds_read_b64_tr_b16 v[228:229], v250 offset:4096
    ds_read_b64_tr_b16 v[232:233], v251 offset:4096
    v_max3_f32 v252, v172, v173, v174
    v_max3_f32 v253, v175, v176, v177
    v_max3_f32 v252, v252, v178, v179
    v_max3_f32 v253, v253, v180, v181
    v_max3_f32 v252, v252, v182, v183
    v_max3_f32 v253, v253, v184, v185
    v_max3_f32 v252, v252, v186, v187
    v_max3_f32 v253, v253, v188, v189
    v_max3_f32 v252, v252, v190, v191
    v_max3_f32 v253, v253, v192, v193
    v_max3_f32 v252, v252, v194, v195
    v_max_f32 v252, v252, v253
    v_cmp_lt_f32 vcc, s53, v252
    s_cbranch_vccnz K1_RARE7
K1_BACK7:
    v_exp_f32 v172, v172
    v_exp_f32 v173, v173
    v_exp_f32 v174, v174
    v_exp_f32 v175, v175
    v_exp_f32 v184, v184
    v_exp_f32 v185, v185
    v_exp_f32 v186, v186
    v_exp_f32 v187, v187
    v_cvt_pk_bf16_f32 v172, v172, v173
    v_cvt_pk_bf16_f32 v173, v174, v175
    v_cvt_pk_bf16_f32 v174, v184, v185
    v_cvt_pk_bf16_f32 v175, v186, v187
    s_waitcnt lgkmcnt(0)
    s_waitcnt vmcnt(0)
    ds_read_b64_tr_b16 v[198:199], v244 offset:8192
    ds_read_b64_tr_b16 v[202:203], v245 offset:8192
    ds_read_b64_tr_b16 v[214:215], v246 offset:8192
    ds_read_b64_tr_b16 v[218:219], v247 offset:8192
    ds_read_b64_tr_b16 v[222:223], v248 offset:8192
    ds_read_b64_tr_b16 v[226:227], v249 offset:8192
    ds_read_b64_tr_b16 v[230:231], v250 offset:8192
    ds_read_b64_tr_b16 v[234:235], v251 offset:8192
    v_exp_f32 v176, v176
    v_exp_f32 v177, v177
    v_exp_f32 v178, v178
    v_exp_f32 v179, v179
    v_exp_f32 v188, v188
    v_exp_f32 v189, v189
    v_exp_f32 v190, v190
    v_exp_f32 v191, v191
    v_cvt_pk_bf16_f32 v176, v176, v177
    v_cvt_pk_bf16_f32 v177, v178, v179
    v_cvt_pk_bf16_f32 v178, v188, v189
    v_cvt_pk_bf16_f32 v179, v190, v191
    v_exp_f32 v180, v180
    v_exp_f32 v181, v181
    v_exp_f32 v182, v182
    v_exp_f32 v183, v183
    v_exp_f32 v192, v192
    v_exp_f32 v193, v193
    v_exp_f32 v194, v194
    v_exp_f32 v195, v195
    v_cvt_pk_bf16_f32 v180, v180, v181
    v_cvt_pk_bf16_f32 v181, v182, v183
    v_cvt_pk_bf16_f32 v182, v192, v193
    v_cvt_pk_bf16_f32 v183, v194, v195
    v_mfma_f32_16x16x32_bf16 v[96:99], v[168:171], v[172:175], v[96:99]
    v_mfma_f32_16x16x32_bf16 v[100:103], v[168:171], v[176:179], v[100:103]
    v_mfma_f32_16x16x32_bf16 v[104:107], v[168:171], v[180:183], v[104:107]
    s_waitcnt lgkmcnt(0)
    v_mfma_f32_16x16x32_bf16 v[0:3], v[196:199], v[172:175], v[0:3]
    v_mfma_f32_16x16x32_bf16 v[4:7], v[196:199], v[176:179], v[4:7]
    v_mfma_f32_16x16x32_bf16 v[8:11], v[196:199], v[180:183], v[8:11]
    v_mfma_f32_16x16x32_bf16 v[12:15], v[200:203], v[172:175], v[12:15]
    v_mfma_f32_16x16x32_bf16 v[16:19], v[200:203], v[176:179], v[16:19]
    v_mfma_f32_16x16x32_bf16 v[20:23], v[200:203], v[180:183], v[20:23]
    v_mfma_f32_16x16x32_bf16 v[24:27], v[212:215], v[172:175], v[24:27]
    v_mfma_f32_16x16x32_bf16 v[28:31], v[212:215], v[176:179], v[28:31]
    v_mfma_f32_16x16x32_bf16 v[32:35], v[212:215], v[180:183], v[32:35]
    v_mfma_f32_16x16x32_bf16 v[36:39], v[216:219], v[172:175], v[36:39]
    v_mfma_f32_16x16x32_bf16 v[40:43], v[216:219], v[176:179], v[40:43]
    v_mfma_f32_16x16x32_bf16 v[44:47], v[216:219], v[180:183], v[44:47]
    v_mfma_f32_16x16x32_bf16 v[48:51], v[220:223], v[172:175], v[48:51]
    v_mfma_f32_16x16x32_bf16 v[52:55], v[220:223], v[176:179], v[52:55]
    v_mfma_f32_16x16x32_bf16 v[56:59], v[220:223], v[180:183], v[56:59]
    v_mfma_f32_16x16x32_bf16 v[60:63], v[224:227], v[172:175], v[60:63]
    v_mfma_f32_16x16x32_bf16 v[64:67], v[224:227], v[176:179], v[64:67]
    v_mfma_f32_16x16x32_bf16 v[68:71], v[224:227], v[180:183], v[68:71]
    v_mfma_f32_16x16x32_bf16 v[72:75], v[228:231], v[172:175], v[72:75]
    v_mfma_f32_16x16x32_bf16 v[76:79], v[228:231], v[176:179], v[76:79]
    v_mfma_f32_16x16x32_bf16 v[80:83], v[228:231], v[180:183], v[80:83]
    v_mfma_f32_16x16x32_bf16 v[84:87], v[232:235], v[172:175], v[84:87]
    v_mfma_f32_16x16x32_bf16 v[88:91], v[232:235], v[176:179], v[88:91]
    v_mfma_f32_16x16x32_bf16 v[92:95], v[232:235], v[180:183], v[92:95]
    v_mbcnt_lo_u32_b32 v172, -1, 0
    v_mbcnt_hi_u32_b32 v172, -1, v172
    v_and_b32 v174, 15, v172
    v_lshlrev_b32 v177, 3, v174
    v_add_u32 v176, s42, v177
    v_add_u32 v178, 61440, v177
    v_add_u32 v179, 122880, v177
    v_mov_b32 v157, v96
    ds_write_b64 v176, v[156:157] offset:16384
    v_mov_b32 v161, v100
    ds_write_b64 v176, v[160:161] offset:16512
    v_mov_b32 v165, v104
    ds_write_b64 v176, v[164:165] offset:16640
    s_waitcnt lgkmcnt(0)
    s_barrier
    ds_read_b64 v[108:109], v177 offset:16384
    ds_read_b64 v[110:111], v177 offset:36864
    ds_read_b64 v[112:113], v177 offset:57344
    ds_read_b64 v[114:115], v178 offset:16384
    ds_read_b64 v[116:117], v178 offset:36864
    ds_read_b64 v[118:119], v178 offset:57344
    ds_read_b64 v[120:121], v179 offset:16384
    ds_read_b64 v[122:123], v179 offset:36864
    ds_read_b64 v[124:125], v177 offset:16512
    ds_read_b64 v[126:127], v177 offset:36992
    ds_read_b64 v[128:129], v177 offset:57472
    ds_read_b64 v[130:131], v178 offset:16512
    ds_read_b64 v[132:133], v178 offset:36992
    ds_read_b64 v[134:135], v178 offset:57472
    ds_read_b64 v[136:137], v179 offset:16512
    ds_read_b64 v[138:139], v179 offset:36992
    ds_read_b64 v[140:141], v177 offset:16640
    ds_read_b64 v[142:143], v177 offset:37120
    ds_read_b64 v[144:145], v177 offset:57600
    ds_read_b64 v[146:147], v178 offset:16640
    ds_read_b64 v[148:149], v178 offset:37120
    ds_read_b64 v[150:151], v178 offset:57600
    ds_read_b64 v[152:153], v179 offset:16640
    ds_read_b64 v[154:155], v179 offset:37120
    s_waitcnt lgkmcnt(15)
    v_min3_f32 v200, v108, v110, v112
    v_min3_f32 v200, v200, v114, v116
    v_min3_f32 v200, v200, v118, v120
    v_min_f32 v200, v200, v122
    v_sub_f32 v108, v200, v108
    v_sub_f32 v110, v200, v110
    v_sub_f32 v112, v200, v112
    v_sub_f32 v114, v200, v114
    v_sub_f32 v116, v200, v116
    v_sub_f32 v118, v200, v118
    v_sub_f32 v120, v200, v120
    v_sub_f32 v122, v200, v122
    v_sub_f32 v196, v200, v156
    v_exp_f32 v108, v108
    v_exp_f32 v110, v110
    v_exp_f32 v112, v112
    v_exp_f32 v114, v114
    v_exp_f32 v116, v116
    v_exp_f32 v118, v118
    v_exp_f32 v120, v120
    v_exp_f32 v122, v122
    v_exp_f32 v196, v196
    v_mul_f32 v204, v108, v109
    v_fmac_f32 v204, v110, v111
    v_fmac_f32 v204, v112, v113
    v_fmac_f32 v204, v114, v115
    v_fmac_f32 v204, v116, v117
    v_fmac_f32 v204, v118, v119
    v_fmac_f32 v204, v120, v121
    v_fmac_f32 v204, v122, v123
    v_rcp_f32 v204, v204
    s_nop 0
    v_mul_f32 v196, v196, v204
    s_waitcnt lgkmcnt(8)
    v_min3_f32 v201, v124, v126, v128
    v_min3_f32 v201, v201, v130, v132
    v_min3_f32 v201, v201, v134, v136
    v_min_f32 v201, v201, v138
    v_sub_f32 v124, v201, v124
    v_sub_f32 v126, v201, v126
    v_sub_f32 v128, v201, v128
    v_sub_f32 v130, v201, v130
    v_sub_f32 v132, v201, v132
    v_sub_f32 v134, v201, v134
    v_sub_f32 v136, v201, v136
    v_sub_f32 v138, v201, v138
    v_sub_f32 v197, v201, v160
    v_exp_f32 v124, v124
    v_exp_f32 v126, v126
    v_exp_f32 v128, v128
    v_exp_f32 v130, v130
    v_exp_f32 v132, v132
    v_exp_f32 v134, v134
    v_exp_f32 v136, v136
    v_exp_f32 v138, v138
    v_exp_f32 v197, v197
    v_mul_f32 v205, v124, v125
    v_fmac_f32 v205, v126, v127
    v_fmac_f32 v205, v128, v129
    v_fmac_f32 v205, v130, v131
    v_fmac_f32 v205, v132, v133
    v_fmac_f32 v205, v134, v135
    v_fmac_f32 v205, v136, v137
    v_fmac_f32 v205, v138, v139
    v_rcp_f32 v205, v205
    s_nop 0
    v_mul_f32 v197, v197, v205
    s_waitcnt lgkmcnt(0)
    v_min3_f32 v202, v140, v142, v144
    v_min3_f32 v202, v202, v146, v148
    v_min3_f32 v202, v202, v150, v152
    v_min_f32 v202, v202, v154
    v_sub_f32 v140, v202, v140
    v_sub_f32 v142, v202, v142
    v_sub_f32 v144, v202, v144
    v_sub_f32 v146, v202, v146
    v_sub_f32 v148, v202, v148
    v_sub_f32 v150, v202, v150
    v_sub_f32 v152, v202, v152
    v_sub_f32 v154, v202, v154
    v_sub_f32 v198, v202, v164
    v_exp_f32 v140, v140
    v_exp_f32 v142, v142
    v_exp_f32 v144, v144
    v_exp_f32 v146, v146
    v_exp_f32 v148, v148
    v_exp_f32 v150, v150
    v_exp_f32 v152, v152
    v_exp_f32 v154, v154
    v_exp_f32 v198, v198
    v_mul_f32 v206, v140, v141
    v_fmac_f32 v206, v142, v143
    v_fmac_f32 v206, v144, v145
    v_fmac_f32 v206, v146, v147
    v_fmac_f32 v206, v148, v149
    v_fmac_f32 v206, v150, v151
    v_fmac_f32 v206, v152, v153
    v_fmac_f32 v206, v154, v155
    v_rcp_f32 v206, v206
    s_nop 0
    v_mul_f32 v198, v198, v206
    v_lshlrev_b32 v177, 3, v172
    v_add_u32 v176, s42, v177
    v_mul_f32 v0, v196, v0
    v_mul_f32 v1, v196, v1
    v_mul_f32 v2, v196, v2
    v_mul_f32 v3, v196, v3
    v_cvt_pk_bf16_f32 v0, v0, v1
    v_cvt_pk_bf16_f32 v1, v2, v3
    ds_write_b64 v176, v[0:1] offset:4096
    v_mul_f32 v4, v197, v4
    v_mul_f32 v5, v197, v5
    v_mul_f32 v6, v197, v6
    v_mul_f32 v7, v197, v7
    v_cvt_pk_bf16_f32 v4, v4, v5
    v_cvt_pk_bf16_f32 v5, v6, v7
    ds_write_b64 v176, v[4:5] offset:4608
    v_mul_f32 v8, v198, v8
    v_mul_f32 v9, v198, v9
    v_mul_f32 v10, v198, v10
    v_mul_f32 v11, v198, v11
    v_cvt_pk_bf16_f32 v8, v8, v9
    v_cvt_pk_bf16_f32 v9, v10, v11
    ds_write_b64 v176, v[8:9] offset:5120
    v_mul_f32 v12, v196, v12
    v_mul_f32 v13, v196, v13
    v_mul_f32 v14, v196, v14
    v_mul_f32 v15, v196, v15
    v_cvt_pk_bf16_f32 v12, v12, v13
    v_cvt_pk_bf16_f32 v13, v14, v15
    ds_write_b64 v176, v[12:13] offset:5632
    v_mul_f32 v16, v197, v16
    v_mul_f32 v17, v197, v17
    v_mul_f32 v18, v197, v18
    v_mul_f32 v19, v197, v19
    v_cvt_pk_bf16_f32 v16, v16, v17
    v_cvt_pk_bf16_f32 v17, v18, v19
    ds_write_b64 v176, v[16:17] offset:6144
    v_mul_f32 v20, v198, v20
    v_mul_f32 v21, v198, v21
    v_mul_f32 v22, v198, v22
    v_mul_f32 v23, v198, v23
    v_cvt_pk_bf16_f32 v20, v20, v21
    v_cvt_pk_bf16_f32 v21, v22, v23
    ds_write_b64 v176, v[20:21] offset:6656
    v_mul_f32 v24, v196, v24
    v_mul_f32 v25, v196, v25
    v_mul_f32 v26, v196, v26
    v_mul_f32 v27, v196, v27
    v_cvt_pk_bf16_f32 v24, v24, v25
    v_cvt_pk_bf16_f32 v25, v26, v27
    ds_write_b64 v176, v[24:25] offset:7168
    v_mul_f32 v28, v197, v28
    v_mul_f32 v29, v197, v29
    v_mul_f32 v30, v197, v30
    v_mul_f32 v31, v197, v31
    v_cvt_pk_bf16_f32 v28, v28, v29
    v_cvt_pk_bf16_f32 v29, v30, v31
    ds_write_b64 v176, v[28:29] offset:7680
    v_mul_f32 v32, v198, v32
    v_mul_f32 v33, v198, v33
    v_mul_f32 v34, v198, v34
    v_mul_f32 v35, v198, v35
    v_cvt_pk_bf16_f32 v32, v32, v33
    v_cvt_pk_bf16_f32 v33, v34, v35
    ds_write_b64 v176, v[32:33] offset:8192
    v_mul_f32 v36, v196, v36
    v_mul_f32 v37, v196, v37
    v_mul_f32 v38, v196, v38
    v_mul_f32 v39, v196, v39
    v_cvt_pk_bf16_f32 v36, v36, v37
    v_cvt_pk_bf16_f32 v37, v38, v39
    ds_write_b64 v176, v[36:37] offset:8704
    v_mul_f32 v40, v197, v40
    v_mul_f32 v41, v197, v41
    v_mul_f32 v42, v197, v42
    v_mul_f32 v43, v197, v43
    v_cvt_pk_bf16_f32 v40, v40, v41
    v_cvt_pk_bf16_f32 v41, v42, v43
    ds_write_b64 v176, v[40:41] offset:9216
    v_mul_f32 v44, v198, v44
    v_mul_f32 v45, v198, v45
    v_mul_f32 v46, v198, v46
    v_mul_f32 v47, v198, v47
    v_cvt_pk_bf16_f32 v44, v44, v45
    v_cvt_pk_bf16_f32 v45, v46, v47
    ds_write_b64 v176, v[44:45] offset:9728
    v_mul_f32 v48, v196, v48
    v_mul_f32 v49, v196, v49
    v_mul_f32 v50, v196, v50
    v_mul_f32 v51, v196, v51
    v_cvt_pk_bf16_f32 v48, v48, v49
    v_cvt_pk_bf16_f32 v49, v50, v51
    ds_write_b64 v176, v[48:49] offset:10240
    v_mul_f32 v52, v197, v52
    v_mul_f32 v53, v197, v53
    v_mul_f32 v54, v197, v54
    v_mul_f32 v55, v197, v55
    v_cvt_pk_bf16_f32 v52, v52, v53
    v_cvt_pk_bf16_f32 v53, v54, v55
    ds_write_b64 v176, v[52:53] offset:10752
    v_mul_f32 v56, v198, v56
    v_mul_f32 v57, v198, v57
    v_mul_f32 v58, v198, v58
    v_mul_f32 v59, v198, v59
    v_cvt_pk_bf16_f32 v56, v56, v57
    v_cvt_pk_bf16_f32 v57, v58, v59
    ds_write_b64 v176, v[56:57] offset:11264
    v_mul_f32 v60, v196, v60
    v_mul_f32 v61, v196, v61
    v_mul_f32 v62, v196, v62
    v_mul_f32 v63, v196, v63
    v_cvt_pk_bf16_f32 v60, v60, v61
    v_cvt_pk_bf16_f32 v61, v62, v63
    ds_write_b64 v176, v[60:61] offset:11776
    v_mul_f32 v64, v197, v64
    v_mul_f32 v65, v197, v65
    v_mul_f32 v66, v197, v66
    v_mul_f32 v67, v197, v67
    v_cvt_pk_bf16_f32 v64, v64, v65
    v_cvt_pk_bf16_f32 v65, v66, v67
    ds_write_b64 v176, v[64:65] offset:12288
    v_mul_f32 v68, v198, v68
    v_mul_f32 v69, v198, v69
    v_mul_f32 v70, v198, v70
    v_mul_f32 v71, v198, v71
    v_cvt_pk_bf16_f32 v68, v68, v69
    v_cvt_pk_bf16_f32 v69, v70, v71
    ds_write_b64 v176, v[68:69] offset:12800
    v_mul_f32 v72, v196, v72
    v_mul_f32 v73, v196, v73
    v_mul_f32 v74, v196, v74
    v_mul_f32 v75, v196, v75
    v_cvt_pk_bf16_f32 v72, v72, v73
    v_cvt_pk_bf16_f32 v73, v74, v75
    ds_write_b64 v176, v[72:73] offset:13312
    v_mul_f32 v76, v197, v76
    v_mul_f32 v77, v197, v77
    v_mul_f32 v78, v197, v78
    v_mul_f32 v79, v197, v79
    v_cvt_pk_bf16_f32 v76, v76, v77
    v_cvt_pk_bf16_f32 v77, v78, v79
    ds_write_b64 v176, v[76:77] offset:13824
    v_mul_f32 v80, v198, v80
    v_mul_f32 v81, v198, v81
    v_mul_f32 v82, v198, v82
    v_mul_f32 v83, v198, v83
    v_cvt_pk_bf16_f32 v80, v80, v81
    v_cvt_pk_bf16_f32 v81, v82, v83
    ds_write_b64 v176, v[80:81] offset:14336
    v_mul_f32 v84, v196, v84
    v_mul_f32 v85, v196, v85
    v_mul_f32 v86, v196, v86
    v_mul_f32 v87, v196, v87
    v_cvt_pk_bf16_f32 v84, v84, v85
    v_cvt_pk_bf16_f32 v85, v86, v87
    ds_write_b64 v176, v[84:85] offset:14848
    v_mul_f32 v88, v197, v88
    v_mul_f32 v89, v197, v89
    v_mul_f32 v90, v197, v90
    v_mul_f32 v91, v197, v91
    v_cvt_pk_bf16_f32 v88, v88, v89
    v_cvt_pk_bf16_f32 v89, v90, v91
    ds_write_b64 v176, v[88:89] offset:15360
    v_mul_f32 v92, v198, v92
    v_mul_f32 v93, v198, v93
    v_mul_f32 v94, v198, v94
    v_mul_f32 v95, v198, v95
    v_cvt_pk_bf16_f32 v92, v92, v93
    v_cvt_pk_bf16_f32 v93, v94, v95
    ds_write_b64 v176, v[92:93] offset:15872
    s_mul_i32 s45, s34, 1536
    v_add_u32 v177, s45, v177
    v_add_u32 v178, 61440, v177
    v_add_u32 v179, 122880, v177
    s_mov_b32 s54, 0x3f80
    s_mov_b32 s55, 0x3f800000
    s_lshr_b32 s45, s34, 1
    s_mul_i32 s45, s45, 3072
    s_lshl_b32 s46, s40, 3
    s_add_u32 s45, s45, s46
    v_lshlrev_b32 v181, 4, v172
    v_add_u32 v180, s45, v181
    v_lshrrev_b32 v188, 2, v172
    v_bfe_u32 v189, v172, 3, 2
    v_lshlrev_b32 v189, 5, v189
    v_lshl_add_u32 v189, v188, 7, v189
    v_and_b32 v188, 3, v172
    v_lshl_add_u32 v189, v188, 3, v189
    v_add_u32 v184, s42, v189
    v_xor_b32 v185, 32, v184
    v_xor_b32 v186, 64, v184
    v_xor_b32 v187, 96, v184
    ds_read_b64_tr_b16 v[212:213], v184 offset:0
    ds_read_b64_tr_b16 v[214:215], v184 offset:2048
    ds_read_b64_tr_b16 v[216:217], v185 offset:0
    ds_read_b64_tr_b16 v[218:219], v185 offset:2048
    ds_read_b64_tr_b16 v[220:221], v186 offset:0
    ds_read_b64_tr_b16 v[222:223], v186 offset:2048
    ds_read_b64_tr_b16 v[224:225], v187 offset:0
    ds_read_b64_tr_b16 v[226:227], v187 offset:2048
    s_waitcnt lgkmcnt(8)
    v_mov_b32 v48, 0
    v_mov_b32 v49, 0
    v_mov_b32 v50, 0
    v_mov_b32 v51, 0
    v_mov_b32 v52, 0
    v_mov_b32 v53, 0
    v_mov_b32 v54, 0
    v_mov_b32 v55, 0
    v_mov_b32 v56, 0
    v_mov_b32 v57, 0
    v_mov_b32 v58, 0
    v_mov_b32 v59, 0
    s_barrier
    s_mov_b32 s61, 262144
    s_waitcnt lgkmcnt(6)
    buffer_store_dwordx4 v[212:215], v181, s[28:31], 0 offen offset:0
    s_waitcnt lgkmcnt(4)
    buffer_store_dwordx4 v[216:219], v181, s[28:31], 0 offen offset:1024
    s_waitcnt lgkmcnt(2)
    buffer_store_dwordx4 v[220:223], v181, s[28:31], s61 offen offset:0
    s_waitcnt lgkmcnt(0)
    buffer_store_dwordx4 v[224:227], v181, s[28:31], s61 offen offset:1024
    ds_read_b64 v[0:1], v177 offset:4096
    ds_read_b64 v[2:3], v177 offset:24576
    ds_read_b64 v[4:5], v177 offset:45056
    ds_read_b64 v[6:7], v178 offset:4096
    ds_read_b64 v[8:9], v178 offset:24576
    ds_read_b64 v[10:11], v178 offset:45056
    ds_read_b64 v[12:13], v179 offset:4096
    ds_read_b64 v[14:15], v179 offset:24576
    ds_read_b64 v[16:17], v177 offset:4608
    ds_read_b64 v[18:19], v177 offset:25088
    ds_read_b64 v[20:21], v177 offset:45568
    ds_read_b64 v[22:23], v178 offset:4608
    ds_read_b64 v[24:25], v178 offset:25088
    ds_read_b64 v[26:27], v178 offset:45568
    ds_read_b64 v[28:29], v179 offset:4608
    ds_read_b64 v[30:31], v179 offset:25088
    ds_read_b64 v[32:33], v177 offset:5120
    ds_read_b64 v[34:35], v177 offset:25600
    ds_read_b64 v[36:37], v177 offset:46080
    ds_read_b64 v[38:39], v178 offset:5120
    ds_read_b64 v[40:41], v178 offset:25600
    ds_read_b64 v[42:43], v178 offset:46080
    ds_read_b64 v[44:45], v179 offset:5120
    ds_read_b64 v[46:47], v179 offset:25600
    s_waitcnt lgkmcnt(15)
    v_dot2c_f32_bf16 v48, s54, v0
    v_dot2c_f32_bf16 v49, s55, v0
    v_dot2c_f32_bf16 v50, s54, v1
    v_dot2c_f32_bf16 v51, s55, v1
    v_dot2c_f32_bf16 v48, s54, v2
    v_dot2c_f32_bf16 v49, s55, v2
    v_dot2c_f32_bf16 v50, s54, v3
    v_dot2c_f32_bf16 v51, s55, v3
    v_dot2c_f32_bf16 v48, s54, v4
    v_dot2c_f32_bf16 v49, s55, v4
    v_dot2c_f32_bf16 v50, s54, v5
    v_dot2c_f32_bf16 v51, s55, v5
    v_dot2c_f32_bf16 v48, s54, v6
    v_dot2c_f32_bf16 v49, s55, v6
    v_dot2c_f32_bf16 v50, s54, v7
    v_dot2c_f32_bf16 v51, s55, v7
    v_dot2c_f32_bf16 v48, s54, v8
    v_dot2c_f32_bf16 v49, s55, v8
    v_dot2c_f32_bf16 v50, s54, v9
    v_dot2c_f32_bf16 v51, s55, v9
    v_dot2c_f32_bf16 v48, s54, v10
    v_dot2c_f32_bf16 v49, s55, v10
    v_dot2c_f32_bf16 v50, s54, v11
    v_dot2c_f32_bf16 v51, s55, v11
    v_dot2c_f32_bf16 v48, s54, v12
    v_dot2c_f32_bf16 v49, s55, v12
    v_dot2c_f32_bf16 v50, s54, v13
    v_dot2c_f32_bf16 v51, s55, v13
    v_dot2c_f32_bf16 v48, s54, v14
    v_dot2c_f32_bf16 v49, s55, v14
    v_dot2c_f32_bf16 v50, s54, v15
    v_dot2c_f32_bf16 v51, s55, v15
    s_nop 0
    v_cvt_pk_bf16_f32 v60, v48, v49
    s_nop 0
    v_cvt_pk_bf16_f32 v61, v50, v51
    buffer_store_dwordx2 v[60:61], v180, s[20:23], 0 offen offset:0
    v_dot2c_f32_bf16 v52, s54, v16
    v_dot2c_f32_bf16 v53, s55, v16
    v_dot2c_f32_bf16 v54, s54, v17
    v_dot2c_f32_bf16 v55, s55, v17
    s_waitcnt lgkmcnt(14)
    v_dot2c_f32_bf16 v52, s54, v18
    v_dot2c_f32_bf16 v53, s55, v18
    v_dot2c_f32_bf16 v54, s54, v19
    v_dot2c_f32_bf16 v55, s55, v19
    s_waitcnt lgkmcnt(13)
    v_dot2c_f32_bf16 v52, s54, v20
    v_dot2c_f32_bf16 v53, s55, v20
    v_dot2c_f32_bf16 v54, s54, v21
    v_dot2c_f32_bf16 v55, s55, v21
    s_waitcnt lgkmcnt(12)
    v_dot2c_f32_bf16 v52, s54, v22
    v_dot2c_f32_bf16 v53, s55, v22
    v_dot2c_f32_bf16 v54, s54, v23
    v_dot2c_f32_bf16 v55, s55, v23
    s_waitcnt lgkmcnt(11)
    v_dot2c_f32_bf16 v52, s54, v24
    v_dot2c_f32_bf16 v53, s55, v24
    v_dot2c_f32_bf16 v54, s54, v25
    v_dot2c_f32_bf16 v55, s55, v25
    s_waitcnt lgkmcnt(10)
    v_dot2c_f32_bf16 v52, s54, v26
    v_dot2c_f32_bf16 v53, s55, v26
    v_dot2c_f32_bf16 v54, s54, v27
    v_dot2c_f32_bf16 v55, s55, v27
    s_waitcnt lgkmcnt(9)
    v_dot2c_f32_bf16 v52, s54, v28
    v_dot2c_f32_bf16 v53, s55, v28
    v_dot2c_f32_bf16 v54, s54, v29
    v_dot2c_f32_bf16 v55, s55, v29
    s_waitcnt lgkmcnt(8)
    v_dot2c_f32_bf16 v52, s54, v30
    v_dot2c_f32_bf16 v53, s55, v30
    v_dot2c_f32_bf16 v54, s54, v31
    v_dot2c_f32_bf16 v55, s55, v31
    s_nop 0
    v_cvt_pk_bf16_f32 v62, v52, v53
    s_nop 0
    v_cvt_pk_bf16_f32 v63, v54, v55
    buffer_store_dwordx2 v[62:63], v180, s[20:23], 0 offen offset:1024
    s_waitcnt lgkmcnt(7)
    v_dot2c_f32_bf16 v56, s54, v32
    v_dot2c_f32_bf16 v57, s55, v32
    v_dot2c_f32_bf16 v58, s54, v33
    v_dot2c_f32_bf16 v59, s55, v33
    s_waitcnt lgkmcnt(6)
    v_dot2c_f32_bf16 v56, s54, v34
    v_dot2c_f32_bf16 v57, s55, v34
    v_dot2c_f32_bf16 v58, s54, v35
    v_dot2c_f32_bf16 v59, s55, v35
    s_waitcnt lgkmcnt(5)
    v_dot2c_f32_bf16 v56, s54, v36
    v_dot2c_f32_bf16 v57, s55, v36
    v_dot2c_f32_bf16 v58, s54, v37
    v_dot2c_f32_bf16 v59, s55, v37
    s_waitcnt lgkmcnt(4)
    v_dot2c_f32_bf16 v56, s54, v38
    v_dot2c_f32_bf16 v57, s55, v38
    v_dot2c_f32_bf16 v58, s54, v39
    v_dot2c_f32_bf16 v59, s55, v39
    s_waitcnt lgkmcnt(3)
    v_dot2c_f32_bf16 v56, s54, v40
    v_dot2c_f32_bf16 v57, s55, v40
    v_dot2c_f32_bf16 v58, s54, v41
    v_dot2c_f32_bf16 v59, s55, v41
    s_waitcnt lgkmcnt(2)
    v_dot2c_f32_bf16 v56, s54, v42
    v_dot2c_f32_bf16 v57, s55, v42
    v_dot2c_f32_bf16 v58, s54, v43
    v_dot2c_f32_bf16 v59, s55, v43
    s_waitcnt lgkmcnt(1)
    v_dot2c_f32_bf16 v56, s54, v44
    v_dot2c_f32_bf16 v57, s55, v44
    v_dot2c_f32_bf16 v58, s54, v45
    v_dot2c_f32_bf16 v59, s55, v45
    s_waitcnt lgkmcnt(0)
    v_dot2c_f32_bf16 v56, s54, v46
    v_dot2c_f32_bf16 v57, s55, v46
    v_dot2c_f32_bf16 v58, s54, v47
    v_dot2c_f32_bf16 v59, s55, v47
    s_nop 0
    v_cvt_pk_bf16_f32 v64, v56, v57
    s_nop 0
    v_cvt_pk_bf16_f32 v65, v58, v59
    buffer_store_dwordx2 v[64:65], v180, s[20:23], 0 offen offset:2048
K1_END:
    s_endpgm
K1_RARE1:
    s_nop 7
    v_max3_f32 v252, v172, v173, v174
    v_max3_f32 v252, v252, v175, v184
    v_max3_f32 v252, v252, v185, v186
    v_max_f32 v252, v252, v187
    v_mov_b32 v253, v252
    s_nop 1
    v_permlane32_swap_b32 v252, v253
    v_max_f32 v252, v252, v253
    v_mov_b32 v253, v252
    s_nop 1
    v_permlane16_swap_b32 v252, v253
    v_max_f32 v252, v252, v253
    v_max_f32 v252, 0, v252
    v_exp_f32 v254, -v252
    v_sub_f32 v172, v172, v252
    v_sub_f32 v173, v173, v252
    v_sub_f32 v174, v174, v252
    v_sub_f32 v175, v175, v252
    v_sub_f32 v184, v184, v252
    v_sub_f32 v185, v185, v252
    v_sub_f32 v186, v186, v252
    v_sub_f32 v187, v187, v252
    v_sub_f32 v156, v156, v252
    v_sub_f32 v157, v157, v252
    v_sub_f32 v158, v158, v252
    v_sub_f32 v159, v159, v252
    v_mul_f32 v96, v254, v96
    v_mul_f32 v97, v254, v97
    v_mul_f32 v98, v254, v98
    v_mul_f32 v99, v254, v99
    v_mul_f32 v0, v254, v0
    v_mul_f32 v1, v254, v1
    v_mul_f32 v2, v254, v2
    v_mul_f32 v3, v254, v3
    v_mul_f32 v12, v254, v12
    v_mul_f32 v13, v254, v13
    v_mul_f32 v14, v254, v14
    v_mul_f32 v15, v254, v15
    v_mul_f32 v24, v254, v24
    v_mul_f32 v25, v254, v25
    v_mul_f32 v26, v254, v26
    v_mul_f32 v27, v254, v27
    v_mul_f32 v36, v254, v36
    v_mul_f32 v37, v254, v37
    v_mul_f32 v38, v254, v38
    v_mul_f32 v39, v254, v39
    v_mul_f32 v48, v254, v48
    v_mul_f32 v49, v254, v49
    v_mul_f32 v50, v254, v50
    v_mul_f32 v51, v254, v51
    v_mul_f32 v60, v254, v60
    v_mul_f32 v61, v254, v61
    v_mul_f32 v62, v254, v62
    v_mul_f32 v63, v254, v63
    v_mul_f32 v72, v254, v72
    v_mul_f32 v73, v254, v73
    v_mul_f32 v74, v254, v74
    v_mul_f32 v75, v254, v75
    v_mul_f32 v84, v254, v84
    v_mul_f32 v85, v254, v85
    v_mul_f32 v86, v254, v86
    v_mul_f32 v87, v254, v87
    v_max3_f32 v252, v176, v177, v178
    v_max3_f32 v252, v252, v179, v188
    v_max3_f32 v252, v252, v189, v190
    v_max_f32 v252, v252, v191
    v_mov_b32 v253, v252
    s_nop 1
    v_permlane32_swap_b32 v252, v253
    v_max_f32 v252, v252, v253
    v_mov_b32 v253, v252
    s_nop 1
    v_permlane16_swap_b32 v252, v253
    v_max_f32 v252, v252, v253
    v_max_f32 v252, 0, v252
    v_exp_f32 v254, -v252
    v_sub_f32 v176, v176, v252
    v_sub_f32 v177, v177, v252
    v_sub_f32 v178, v178, v252
    v_sub_f32 v179, v179, v252
    v_sub_f32 v188, v188, v252
    v_sub_f32 v189, v189, v252
    v_sub_f32 v190, v190, v252
    v_sub_f32 v191, v191, v252
    v_sub_f32 v160, v160, v252
    v_sub_f32 v161, v161, v252
    v_sub_f32 v162, v162, v252
    v_sub_f32 v163, v163, v252
    v_mul_f32 v100, v254, v100
    v_mul_f32 v101, v254, v101
    v_mul_f32 v102, v254, v102
    v_mul_f32 v103, v254, v103
    v_mul_f32 v4, v254, v4
    v_mul_f32 v5, v254, v5
    v_mul_f32 v6, v254, v6
    v_mul_f32 v7, v254, v7
    v_mul_f32 v16, v254, v16
    v_mul_f32 v17, v254, v17
    v_mul_f32 v18, v254, v18
    v_mul_f32 v19, v254, v19
    v_mul_f32 v28, v254, v28
    v_mul_f32 v29, v254, v29
    v_mul_f32 v30, v254, v30
    v_mul_f32 v31, v254, v31
    v_mul_f32 v40, v254, v40
    v_mul_f32 v41, v254, v41
    v_mul_f32 v42, v254, v42
    v_mul_f32 v43, v254, v43
    v_mul_f32 v52, v254, v52
    v_mul_f32 v53, v254, v53
    v_mul_f32 v54, v254, v54
    v_mul_f32 v55, v254, v55
    v_mul_f32 v64, v254, v64
    v_mul_f32 v65, v254, v65
    v_mul_f32 v66, v254, v66
    v_mul_f32 v67, v254, v67
    v_mul_f32 v76, v254, v76
    v_mul_f32 v77, v254, v77
    v_mul_f32 v78, v254, v78
    v_mul_f32 v79, v254, v79
    v_mul_f32 v88, v254, v88
    v_mul_f32 v89, v254, v89
    v_mul_f32 v90, v254, v90
    v_mul_f32 v91, v254, v91
    v_max3_f32 v252, v180, v181, v182
    v_max3_f32 v252, v252, v183, v192
    v_max3_f32 v252, v252, v193, v194
    v_max_f32 v252, v252, v195
    v_mov_b32 v253, v252
    s_nop 1
    v_permlane32_swap_b32 v252, v253
    v_max_f32 v252, v252, v253
    v_mov_b32 v253, v252
    s_nop 1
    v_permlane16_swap_b32 v252, v253
    v_max_f32 v252, v252, v253
    v_max_f32 v252, 0, v252
    v_exp_f32 v254, -v252
    v_sub_f32 v180, v180, v252
    v_sub_f32 v181, v181, v252
    v_sub_f32 v182, v182, v252
    v_sub_f32 v183, v183, v252
    v_sub_f32 v192, v192, v252
    v_sub_f32 v193, v193, v252
    v_sub_f32 v194, v194, v252
    v_sub_f32 v195, v195, v252
    v_sub_f32 v164, v164, v252
    v_sub_f32 v165, v165, v252
    v_sub_f32 v166, v166, v252
    v_sub_f32 v167, v167, v252
    v_mul_f32 v104, v254, v104
    v_mul_f32 v105, v254, v105
    v_mul_f32 v106, v254, v106
    v_mul_f32 v107, v254, v107
    v_mul_f32 v8, v254, v8
    v_mul_f32 v9, v254, v9
    v_mul_f32 v10, v254, v10
    v_mul_f32 v11, v254, v11
    v_mul_f32 v20, v254, v20
    v_mul_f32 v21, v254, v21
    v_mul_f32 v22, v254, v22
    v_mul_f32 v23, v254, v23
    v_mul_f32 v32, v254, v32
    v_mul_f32 v33, v254, v33
    v_mul_f32 v34, v254, v34
    v_mul_f32 v35, v254, v35
    v_mul_f32 v44, v254, v44
    v_mul_f32 v45, v254, v45
    v_mul_f32 v46, v254, v46
    v_mul_f32 v47, v254, v47
    v_mul_f32 v56, v254, v56
    v_mul_f32 v57, v254, v57
    v_mul_f32 v58, v254, v58
    v_mul_f32 v59, v254, v59
    v_mul_f32 v68, v254, v68
    v_mul_f32 v69, v254, v69
    v_mul_f32 v70, v254, v70
    v_mul_f32 v71, v254, v71
    v_mul_f32 v80, v254, v80
    v_mul_f32 v81, v254, v81
    v_mul_f32 v82, v254, v82
    v_mul_f32 v83, v254, v83
    v_mul_f32 v92, v254, v92
    v_mul_f32 v93, v254, v93
    v_mul_f32 v94, v254, v94
    v_mul_f32 v95, v254, v95
    s_nop 1
    s_branch K1_BACK1
K1_RARE2:
    s_nop 7
    v_max3_f32 v252, v172, v173, v174
    v_max3_f32 v252, v252, v175, v184
    v_max3_f32 v252, v252, v185, v186
    v_max_f32 v252, v252, v187
    v_mov_b32 v253, v252
    s_nop 1
    v_permlane32_swap_b32 v252, v253
    v_max_f32 v252, v252, v253
    v_mov_b32 v253, v252
    s_nop 1
    v_permlane16_swap_b32 v252, v253
    v_max_f32 v252, v252, v253
    v_max_f32 v252, 0, v252
    v_exp_f32 v254, -v252
    v_sub_f32 v172, v172, v252
    v_sub_f32 v173, v173, v252
    v_sub_f32 v174, v174, v252
    v_sub_f32 v175, v175, v252
    v_sub_f32 v184, v184, v252
    v_sub_f32 v185, v185, v252
    v_sub_f32 v186, v186, v252
    v_sub_f32 v187, v187, v252
    v_sub_f32 v156, v156, v252
    v_sub_f32 v157, v157, v252
    v_sub_f32 v158, v158, v252
    v_sub_f32 v159, v159, v252
    v_mul_f32 v96, v254, v96
    v_mul_f32 v97, v254, v97
    v_mul_f32 v98, v254, v98
    v_mul_f32 v99, v254, v99
    v_mul_f32 v0, v254, v0
    v_mul_f32 v1, v254, v1
    v_mul_f32 v2, v254, v2
    v_mul_f32 v3, v254, v3
    v_mul_f32 v12, v254, v12
    v_mul_f32 v13, v254, v13
    v_mul_f32 v14, v254, v14
    v_mul_f32 v15, v254, v15
    v_mul_f32 v24, v254, v24
    v_mul_f32 v25, v254, v25
    v_mul_f32 v26, v254, v26
    v_mul_f32 v27, v254, v27
    v_mul_f32 v36, v254, v36
    v_mul_f32 v37, v254, v37
    v_mul_f32 v38, v254, v38
    v_mul_f32 v39, v254, v39
    v_mul_f32 v48, v254, v48
    v_mul_f32 v49, v254, v49
    v_mul_f32 v50, v254, v50
    v_mul_f32 v51, v254, v51
    v_mul_f32 v60, v254, v60
    v_mul_f32 v61, v254, v61
    v_mul_f32 v62, v254, v62
    v_mul_f32 v63, v254, v63
    v_mul_f32 v72, v254, v72
    v_mul_f32 v73, v254, v73
    v_mul_f32 v74, v254, v74
    v_mul_f32 v75, v254, v75
    v_mul_f32 v84, v254, v84
    v_mul_f32 v85, v254, v85
    v_mul_f32 v86, v254, v86
    v_mul_f32 v87, v254, v87
    v_max3_f32 v252, v176, v177, v178
    v_max3_f32 v252, v252, v179, v188
    v_max3_f32 v252, v252, v189, v190
    v_max_f32 v252, v252, v191
    v_mov_b32 v253, v252
    s_nop 1
    v_permlane32_swap_b32 v252, v253
    v_max_f32 v252, v252, v253
    v_mov_b32 v253, v252
    s_nop 1
    v_permlane16_swap_b32 v252, v253
    v_max_f32 v252, v252, v253
    v_max_f32 v252, 0, v252
    v_exp_f32 v254, -v252
    v_sub_f32 v176, v176, v252
    v_sub_f32 v177, v177, v252
    v_sub_f32 v178, v178, v252
    v_sub_f32 v179, v179, v252
    v_sub_f32 v188, v188, v252
    v_sub_f32 v189, v189, v252
    v_sub_f32 v190, v190, v252
    v_sub_f32 v191, v191, v252
    v_sub_f32 v160, v160, v252
    v_sub_f32 v161, v161, v252
    v_sub_f32 v162, v162, v252
    v_sub_f32 v163, v163, v252
    v_mul_f32 v100, v254, v100
    v_mul_f32 v101, v254, v101
    v_mul_f32 v102, v254, v102
    v_mul_f32 v103, v254, v103
    v_mul_f32 v4, v254, v4
    v_mul_f32 v5, v254, v5
    v_mul_f32 v6, v254, v6
    v_mul_f32 v7, v254, v7
    v_mul_f32 v16, v254, v16
    v_mul_f32 v17, v254, v17
    v_mul_f32 v18, v254, v18
    v_mul_f32 v19, v254, v19
    v_mul_f32 v28, v254, v28
    v_mul_f32 v29, v254, v29
    v_mul_f32 v30, v254, v30
    v_mul_f32 v31, v254, v31
    v_mul_f32 v40, v254, v40
    v_mul_f32 v41, v254, v41
    v_mul_f32 v42, v254, v42
    v_mul_f32 v43, v254, v43
    v_mul_f32 v52, v254, v52
    v_mul_f32 v53, v254, v53
    v_mul_f32 v54, v254, v54
    v_mul_f32 v55, v254, v55
    v_mul_f32 v64, v254, v64
    v_mul_f32 v65, v254, v65
    v_mul_f32 v66, v254, v66
    v_mul_f32 v67, v254, v67
    v_mul_f32 v76, v254, v76
    v_mul_f32 v77, v254, v77
    v_mul_f32 v78, v254, v78
    v_mul_f32 v79, v254, v79
    v_mul_f32 v88, v254, v88
    v_mul_f32 v89, v254, v89
    v_mul_f32 v90, v254, v90
    v_mul_f32 v91, v254, v91
    v_max3_f32 v252, v180, v181, v182
    v_max3_f32 v252, v252, v183, v192
    v_max3_f32 v252, v252, v193, v194
    v_max_f32 v252, v252, v195
    v_mov_b32 v253, v252
    s_nop 1
    v_permlane32_swap_b32 v252, v253
    v_max_f32 v252, v252, v253
    v_mov_b32 v253, v252
    s_nop 1
    v_permlane16_swap_b32 v252, v253
    v_max_f32 v252, v252, v253
    v_max_f32 v252, 0, v252
    v_exp_f32 v254, -v252
    v_sub_f32 v180, v180, v252
    v_sub_f32 v181, v181, v252
    v_sub_f32 v182, v182, v252
    v_sub_f32 v183, v183, v252
    v_sub_f32 v192, v192, v252
    v_sub_f32 v193, v193, v252
    v_sub_f32 v194, v194, v252
    v_sub_f32 v195, v195, v252
    v_sub_f32 v164, v164, v252
    v_sub_f32 v165, v165, v252
    v_sub_f32 v166, v166, v252
    v_sub_f32 v167, v167, v252
    v_mul_f32 v104, v254, v104
    v_mul_f32 v105, v254, v105
    v_mul_f32 v106, v254, v106
    v_mul_f32 v107, v254, v107
    v_mul_f32 v8, v254, v8
    v_mul_f32 v9, v254, v9
    v_mul_f32 v10, v254, v10
    v_mul_f32 v11, v254, v11
    v_mul_f32 v20, v254, v20
    v_mul_f32 v21, v254, v21
    v_mul_f32 v22, v254, v22
    v_mul_f32 v23, v254, v23
    v_mul_f32 v32, v254, v32
    v_mul_f32 v33, v254, v33
    v_mul_f32 v34, v254, v34
    v_mul_f32 v35, v254, v35
    v_mul_f32 v44, v254, v44
    v_mul_f32 v45, v254, v45
    v_mul_f32 v46, v254, v46
    v_mul_f32 v47, v254, v47
    v_mul_f32 v56, v254, v56
    v_mul_f32 v57, v254, v57
    v_mul_f32 v58, v254, v58
    v_mul_f32 v59, v254, v59
    v_mul_f32 v68, v254, v68
    v_mul_f32 v69, v254, v69
    v_mul_f32 v70, v254, v70
    v_mul_f32 v71, v254, v71
    v_mul_f32 v80, v254, v80
    v_mul_f32 v81, v254, v81
    v_mul_f32 v82, v254, v82
    v_mul_f32 v83, v254, v83
    v_mul_f32 v92, v254, v92
    v_mul_f32 v93, v254, v93
    v_mul_f32 v94, v254, v94
    v_mul_f32 v95, v254, v95
    s_nop 1
    s_branch K1_BACK2
K1_RARE3:
    s_nop 7
    v_max3_f32 v252, v172, v173, v174
    v_max3_f32 v252, v252, v175, v184
    v_max3_f32 v252, v252, v185, v186
    v_max_f32 v252, v252, v187
    v_mov_b32 v253, v252
    s_nop 1
    v_permlane32_swap_b32 v252, v253
    v_max_f32 v252, v252, v253
    v_mov_b32 v253, v252
    s_nop 1
    v_permlane16_swap_b32 v252, v253
    v_max_f32 v252, v252, v253
    v_max_f32 v252, 0, v252
    v_exp_f32 v254, -v252
    v_sub_f32 v172, v172, v252
    v_sub_f32 v173, v173, v252
    v_sub_f32 v174, v174, v252
    v_sub_f32 v175, v175, v252
    v_sub_f32 v184, v184, v252
    v_sub_f32 v185, v185, v252
    v_sub_f32 v186, v186, v252
    v_sub_f32 v187, v187, v252
    v_sub_f32 v156, v156, v252
    v_sub_f32 v157, v157, v252
    v_sub_f32 v158, v158, v252
    v_sub_f32 v159, v159, v252
    v_mul_f32 v96, v254, v96
    v_mul_f32 v97, v254, v97
    v_mul_f32 v98, v254, v98
    v_mul_f32 v99, v254, v99
    v_mul_f32 v0, v254, v0
    v_mul_f32 v1, v254, v1
    v_mul_f32 v2, v254, v2
    v_mul_f32 v3, v254, v3
    v_mul_f32 v12, v254, v12
    v_mul_f32 v13, v254, v13
    v_mul_f32 v14, v254, v14
    v_mul_f32 v15, v254, v15
    v_mul_f32 v24, v254, v24
    v_mul_f32 v25, v254, v25
    v_mul_f32 v26, v254, v26
    v_mul_f32 v27, v254, v27
    v_mul_f32 v36, v254, v36
    v_mul_f32 v37, v254, v37
    v_mul_f32 v38, v254, v38
    v_mul_f32 v39, v254, v39
    v_mul_f32 v48, v254, v48
    v_mul_f32 v49, v254, v49
    v_mul_f32 v50, v254, v50
    v_mul_f32 v51, v254, v51
    v_mul_f32 v60, v254, v60
    v_mul_f32 v61, v254, v61
    v_mul_f32 v62, v254, v62
    v_mul_f32 v63, v254, v63
    v_mul_f32 v72, v254, v72
    v_mul_f32 v73, v254, v73
    v_mul_f32 v74, v254, v74
    v_mul_f32 v75, v254, v75
    v_mul_f32 v84, v254, v84
    v_mul_f32 v85, v254, v85
    v_mul_f32 v86, v254, v86
    v_mul_f32 v87, v254, v87
    v_max3_f32 v252, v176, v177, v178
    v_max3_f32 v252, v252, v179, v188
    v_max3_f32 v252, v252, v189, v190
    v_max_f32 v252, v252, v191
    v_mov_b32 v253, v252
    s_nop 1
    v_permlane32_swap_b32 v252, v253
    v_max_f32 v252, v252, v253
    v_mov_b32 v253, v252
    s_nop 1
    v_permlane16_swap_b32 v252, v253
    v_max_f32 v252, v252, v253
    v_max_f32 v252, 0, v252
    v_exp_f32 v254, -v252
    v_sub_f32 v176, v176, v252
    v_sub_f32 v177, v177, v252
    v_sub_f32 v178, v178, v252
    v_sub_f32 v179, v179, v252
    v_sub_f32 v188, v188, v252
    v_sub_f32 v189, v189, v252
    v_sub_f32 v190, v190, v252
    v_sub_f32 v191, v191, v252
    v_sub_f32 v160, v160, v252
    v_sub_f32 v161, v161, v252
    v_sub_f32 v162, v162, v252
    v_sub_f32 v163, v163, v252
    v_mul_f32 v100, v254, v100
    v_mul_f32 v101, v254, v101
    v_mul_f32 v102, v254, v102
    v_mul_f32 v103, v254, v103
    v_mul_f32 v4, v254, v4
    v_mul_f32 v5, v254, v5
    v_mul_f32 v6, v254, v6
    v_mul_f32 v7, v254, v7
    v_mul_f32 v16, v254, v16
    v_mul_f32 v17, v254, v17
    v_mul_f32 v18, v254, v18
    v_mul_f32 v19, v254, v19
    v_mul_f32 v28, v254, v28
    v_mul_f32 v29, v254, v29
    v_mul_f32 v30, v254, v30
    v_mul_f32 v31, v254, v31
    v_mul_f32 v40, v254, v40
    v_mul_f32 v41, v254, v41
    v_mul_f32 v42, v254, v42
    v_mul_f32 v43, v254, v43
    v_mul_f32 v52, v254, v52
    v_mul_f32 v53, v254, v53
    v_mul_f32 v54, v254, v54
    v_mul_f32 v55, v254, v55
    v_mul_f32 v64, v254, v64
    v_mul_f32 v65, v254, v65
    v_mul_f32 v66, v254, v66
    v_mul_f32 v67, v254, v67
    v_mul_f32 v76, v254, v76
    v_mul_f32 v77, v254, v77
    v_mul_f32 v78, v254, v78
    v_mul_f32 v79, v254, v79
    v_mul_f32 v88, v254, v88
    v_mul_f32 v89, v254, v89
    v_mul_f32 v90, v254, v90
    v_mul_f32 v91, v254, v91
    v_max3_f32 v252, v180, v181, v182
    v_max3_f32 v252, v252, v183, v192
    v_max3_f32 v252, v252, v193, v194
    v_max_f32 v252, v252, v195
    v_mov_b32 v253, v252
    s_nop 1
    v_permlane32_swap_b32 v252, v253
    v_max_f32 v252, v252, v253
    v_mov_b32 v253, v252
    s_nop 1
    v_permlane16_swap_b32 v252, v253
    v_max_f32 v252, v252, v253
    v_max_f32 v252, 0, v252
    v_exp_f32 v254, -v252
    v_sub_f32 v180, v180, v252
    v_sub_f32 v181, v181, v252
    v_sub_f32 v182, v182, v252
    v_sub_f32 v183, v183, v252
    v_sub_f32 v192, v192, v252
    v_sub_f32 v193, v193, v252
    v_sub_f32 v194, v194, v252
    v_sub_f32 v195, v195, v252
    v_sub_f32 v164, v164, v252
    v_sub_f32 v165, v165, v252
    v_sub_f32 v166, v166, v252
    v_sub_f32 v167, v167, v252
    v_mul_f32 v104, v254, v104
    v_mul_f32 v105, v254, v105
    v_mul_f32 v106, v254, v106
    v_mul_f32 v107, v254, v107
    v_mul_f32 v8, v254, v8
    v_mul_f32 v9, v254, v9
    v_mul_f32 v10, v254, v10
    v_mul_f32 v11, v254, v11
    v_mul_f32 v20, v254, v20
    v_mul_f32 v21, v254, v21
    v_mul_f32 v22, v254, v22
    v_mul_f32 v23, v254, v23
    v_mul_f32 v32, v254, v32
    v_mul_f32 v33, v254, v33
    v_mul_f32 v34, v254, v34
    v_mul_f32 v35, v254, v35
    v_mul_f32 v44, v254, v44
    v_mul_f32 v45, v254, v45
    v_mul_f32 v46, v254, v46
    v_mul_f32 v47, v254, v47
    v_mul_f32 v56, v254, v56
    v_mul_f32 v57, v254, v57
    v_mul_f32 v58, v254, v58
    v_mul_f32 v59, v254, v59
    v_mul_f32 v68, v254, v68
    v_mul_f32 v69, v254, v69
    v_mul_f32 v70, v254, v70
    v_mul_f32 v71, v254, v71
    v_mul_f32 v80, v254, v80
    v_mul_f32 v81, v254, v81
    v_mul_f32 v82, v254, v82
    v_mul_f32 v83, v254, v83
    v_mul_f32 v92, v254, v92
    v_mul_f32 v93, v254, v93
    v_mul_f32 v94, v254, v94
    v_mul_f32 v95, v254, v95
    s_nop 1
    s_branch K1_BACK3
K1_RARE4:
    s_nop 7
    v_max3_f32 v252, v172, v173, v174
    v_max3_f32 v252, v252, v175, v184
    v_max3_f32 v252, v252, v185, v186
    v_max_f32 v252, v252, v187
    v_mov_b32 v253, v252
    s_nop 1
    v_permlane32_swap_b32 v252, v253
    v_max_f32 v252, v252, v253
    v_mov_b32 v253, v252
    s_nop 1
    v_permlane16_swap_b32 v252, v253
    v_max_f32 v252, v252, v253
    v_max_f32 v252, 0, v252
    v_exp_f32 v254, -v252
    v_sub_f32 v172, v172, v252
    v_sub_f32 v173, v173, v252
    v_sub_f32 v174, v174, v252
    v_sub_f32 v175, v175, v252
    v_sub_f32 v184, v184, v252
    v_sub_f32 v185, v185, v252
    v_sub_f32 v186, v186, v252
    v_sub_f32 v187, v187, v252
    v_sub_f32 v156, v156, v252
    v_sub_f32 v157, v157, v252
    v_sub_f32 v158, v158, v252
    v_sub_f32 v159, v159, v252
    v_mul_f32 v96, v254, v96
    v_mul_f32 v97, v254, v97
    v_mul_f32 v98, v254, v98
    v_mul_f32 v99, v254, v99
    v_mul_f32 v0, v254, v0
    v_mul_f32 v1, v254, v1
    v_mul_f32 v2, v254, v2
    v_mul_f32 v3, v254, v3
    v_mul_f32 v12, v254, v12
    v_mul_f32 v13, v254, v13
    v_mul_f32 v14, v254, v14
    v_mul_f32 v15, v254, v15
    v_mul_f32 v24, v254, v24
    v_mul_f32 v25, v254, v25
    v_mul_f32 v26, v254, v26
    v_mul_f32 v27, v254, v27
    v_mul_f32 v36, v254, v36
    v_mul_f32 v37, v254, v37
    v_mul_f32 v38, v254, v38
    v_mul_f32 v39, v254, v39
    v_mul_f32 v48, v254, v48
    v_mul_f32 v49, v254, v49
    v_mul_f32 v50, v254, v50
    v_mul_f32 v51, v254, v51
    v_mul_f32 v60, v254, v60
    v_mul_f32 v61, v254, v61
    v_mul_f32 v62, v254, v62
    v_mul_f32 v63, v254, v63
    v_mul_f32 v72, v254, v72
    v_mul_f32 v73, v254, v73
    v_mul_f32 v74, v254, v74
    v_mul_f32 v75, v254, v75
    v_mul_f32 v84, v254, v84
    v_mul_f32 v85, v254, v85
    v_mul_f32 v86, v254, v86
    v_mul_f32 v87, v254, v87
    v_max3_f32 v252, v176, v177, v178
    v_max3_f32 v252, v252, v179, v188
    v_max3_f32 v252, v252, v189, v190
    v_max_f32 v252, v252, v191
    v_mov_b32 v253, v252
    s_nop 1
    v_permlane32_swap_b32 v252, v253
    v_max_f32 v252, v252, v253
    v_mov_b32 v253, v252
    s_nop 1
    v_permlane16_swap_b32 v252, v253
    v_max_f32 v252, v252, v253
    v_max_f32 v252, 0, v252
    v_exp_f32 v254, -v252
    v_sub_f32 v176, v176, v252
    v_sub_f32 v177, v177, v252
    v_sub_f32 v178, v178, v252
    v_sub_f32 v179, v179, v252
    v_sub_f32 v188, v188, v252
    v_sub_f32 v189, v189, v252
    v_sub_f32 v190, v190, v252
    v_sub_f32 v191, v191, v252
    v_sub_f32 v160, v160, v252
    v_sub_f32 v161, v161, v252
    v_sub_f32 v162, v162, v252
    v_sub_f32 v163, v163, v252
    v_mul_f32 v100, v254, v100
    v_mul_f32 v101, v254, v101
    v_mul_f32 v102, v254, v102
    v_mul_f32 v103, v254, v103
    v_mul_f32 v4, v254, v4
    v_mul_f32 v5, v254, v5
    v_mul_f32 v6, v254, v6
    v_mul_f32 v7, v254, v7
    v_mul_f32 v16, v254, v16
    v_mul_f32 v17, v254, v17
    v_mul_f32 v18, v254, v18
    v_mul_f32 v19, v254, v19
    v_mul_f32 v28, v254, v28
    v_mul_f32 v29, v254, v29
    v_mul_f32 v30, v254, v30
    v_mul_f32 v31, v254, v31
    v_mul_f32 v40, v254, v40
    v_mul_f32 v41, v254, v41
    v_mul_f32 v42, v254, v42
    v_mul_f32 v43, v254, v43
    v_mul_f32 v52, v254, v52
    v_mul_f32 v53, v254, v53
    v_mul_f32 v54, v254, v54
    v_mul_f32 v55, v254, v55
    v_mul_f32 v64, v254, v64
    v_mul_f32 v65, v254, v65
    v_mul_f32 v66, v254, v66
    v_mul_f32 v67, v254, v67
    v_mul_f32 v76, v254, v76
    v_mul_f32 v77, v254, v77
    v_mul_f32 v78, v254, v78
    v_mul_f32 v79, v254, v79
    v_mul_f32 v88, v254, v88
    v_mul_f32 v89, v254, v89
    v_mul_f32 v90, v254, v90
    v_mul_f32 v91, v254, v91
    v_max3_f32 v252, v180, v181, v182
    v_max3_f32 v252, v252, v183, v192
    v_max3_f32 v252, v252, v193, v194
    v_max_f32 v252, v252, v195
    v_mov_b32 v253, v252
    s_nop 1
    v_permlane32_swap_b32 v252, v253
    v_max_f32 v252, v252, v253
    v_mov_b32 v253, v252
    s_nop 1
    v_permlane16_swap_b32 v252, v253
    v_max_f32 v252, v252, v253
    v_max_f32 v252, 0, v252
    v_exp_f32 v254, -v252
    v_sub_f32 v180, v180, v252
    v_sub_f32 v181, v181, v252
    v_sub_f32 v182, v182, v252
    v_sub_f32 v183, v183, v252
    v_sub_f32 v192, v192, v252
    v_sub_f32 v193, v193, v252
    v_sub_f32 v194, v194, v252
    v_sub_f32 v195, v195, v252
    v_sub_f32 v164, v164, v252
    v_sub_f32 v165, v165, v252
    v_sub_f32 v166, v166, v252
    v_sub_f32 v167, v167, v252
    v_mul_f32 v104, v254, v104
    v_mul_f32 v105, v254, v105
    v_mul_f32 v106, v254, v106
    v_mul_f32 v107, v254, v107
    v_mul_f32 v8, v254, v8
    v_mul_f32 v9, v254, v9
    v_mul_f32 v10, v254, v10
    v_mul_f32 v11, v254, v11
    v_mul_f32 v20, v254, v20
    v_mul_f32 v21, v254, v21
    v_mul_f32 v22, v254, v22
    v_mul_f32 v23, v254, v23
    v_mul_f32 v32, v254, v32
    v_mul_f32 v33, v254, v33
    v_mul_f32 v34, v254, v34
    v_mul_f32 v35, v254, v35
    v_mul_f32 v44, v254, v44
    v_mul_f32 v45, v254, v45
    v_mul_f32 v46, v254, v46
    v_mul_f32 v47, v254, v47
    v_mul_f32 v56, v254, v56
    v_mul_f32 v57, v254, v57
    v_mul_f32 v58, v254, v58
    v_mul_f32 v59, v254, v59
    v_mul_f32 v68, v254, v68
    v_mul_f32 v69, v254, v69
    v_mul_f32 v70, v254, v70
    v_mul_f32 v71, v254, v71
    v_mul_f32 v80, v254, v80
    v_mul_f32 v81, v254, v81
    v_mul_f32 v82, v254, v82
    v_mul_f32 v83, v254, v83
    v_mul_f32 v92, v254, v92
    v_mul_f32 v93, v254, v93
    v_mul_f32 v94, v254, v94
    v_mul_f32 v95, v254, v95
    s_nop 1
    s_branch K1_BACK4
K1_RARE5:
    s_nop 7
    v_max3_f32 v252, v172, v173, v174
    v_max3_f32 v252, v252, v175, v184
    v_max3_f32 v252, v252, v185, v186
    v_max_f32 v252, v252, v187
    v_mov_b32 v253, v252
    s_nop 1
    v_permlane32_swap_b32 v252, v253
    v_max_f32 v252, v252, v253
    v_mov_b32 v253, v252
    s_nop 1
    v_permlane16_swap_b32 v252, v253
    v_max_f32 v252, v252, v253
    v_max_f32 v252, 0, v252
    v_exp_f32 v254, -v252
    v_sub_f32 v172, v172, v252
    v_sub_f32 v173, v173, v252
    v_sub_f32 v174, v174, v252
    v_sub_f32 v175, v175, v252
    v_sub_f32 v184, v184, v252
    v_sub_f32 v185, v185, v252
    v_sub_f32 v186, v186, v252
    v_sub_f32 v187, v187, v252
    v_sub_f32 v156, v156, v252
    v_sub_f32 v157, v157, v252
    v_sub_f32 v158, v158, v252
    v_sub_f32 v159, v159, v252
    v_mul_f32 v96, v254, v96
    v_mul_f32 v97, v254, v97
    v_mul_f32 v98, v254, v98
    v_mul_f32 v99, v254, v99
    v_mul_f32 v0, v254, v0
    v_mul_f32 v1, v254, v1
    v_mul_f32 v2, v254, v2
    v_mul_f32 v3, v254, v3
    v_mul_f32 v12, v254, v12
    v_mul_f32 v13, v254, v13
    v_mul_f32 v14, v254, v14
    v_mul_f32 v15, v254, v15
    v_mul_f32 v24, v254, v24
    v_mul_f32 v25, v254, v25
    v_mul_f32 v26, v254, v26
    v_mul_f32 v27, v254, v27
    v_mul_f32 v36, v254, v36
    v_mul_f32 v37, v254, v37
    v_mul_f32 v38, v254, v38
    v_mul_f32 v39, v254, v39
    v_mul_f32 v48, v254, v48
    v_mul_f32 v49, v254, v49
    v_mul_f32 v50, v254, v50
    v_mul_f32 v51, v254, v51
    v_mul_f32 v60, v254, v60
    v_mul_f32 v61, v254, v61
    v_mul_f32 v62, v254, v62
    v_mul_f32 v63, v254, v63
    v_mul_f32 v72, v254, v72
    v_mul_f32 v73, v254, v73
    v_mul_f32 v74, v254, v74
    v_mul_f32 v75, v254, v75
    v_mul_f32 v84, v254, v84
    v_mul_f32 v85, v254, v85
    v_mul_f32 v86, v254, v86
    v_mul_f32 v87, v254, v87
    v_max3_f32 v252, v176, v177, v178
    v_max3_f32 v252, v252, v179, v188
    v_max3_f32 v252, v252, v189, v190
    v_max_f32 v252, v252, v191
    v_mov_b32 v253, v252
    s_nop 1
    v_permlane32_swap_b32 v252, v253
    v_max_f32 v252, v252, v253
    v_mov_b32 v253, v252
    s_nop 1
    v_permlane16_swap_b32 v252, v253
    v_max_f32 v252, v252, v253
    v_max_f32 v252, 0, v252
    v_exp_f32 v254, -v252
    v_sub_f32 v176, v176, v252
    v_sub_f32 v177, v177, v252
    v_sub_f32 v178, v178, v252
    v_sub_f32 v179, v179, v252
    v_sub_f32 v188, v188, v252
    v_sub_f32 v189, v189, v252
    v_sub_f32 v190, v190, v252
    v_sub_f32 v191, v191, v252
    v_sub_f32 v160, v160, v252
    v_sub_f32 v161, v161, v252
    v_sub_f32 v162, v162, v252
    v_sub_f32 v163, v163, v252
    v_mul_f32 v100, v254, v100
    v_mul_f32 v101, v254, v101
    v_mul_f32 v102, v254, v102
    v_mul_f32 v103, v254, v103
    v_mul_f32 v4, v254, v4
    v_mul_f32 v5, v254, v5
    v_mul_f32 v6, v254, v6
    v_mul_f32 v7, v254, v7
    v_mul_f32 v16, v254, v16
    v_mul_f32 v17, v254, v17
    v_mul_f32 v18, v254, v18
    v_mul_f32 v19, v254, v19
    v_mul_f32 v28, v254, v28
    v_mul_f32 v29, v254, v29
    v_mul_f32 v30, v254, v30
    v_mul_f32 v31, v254, v31
    v_mul_f32 v40, v254, v40
    v_mul_f32 v41, v254, v41
    v_mul_f32 v42, v254, v42
    v_mul_f32 v43, v254, v43
    v_mul_f32 v52, v254, v52
    v_mul_f32 v53, v254, v53
    v_mul_f32 v54, v254, v54
    v_mul_f32 v55, v254, v55
    v_mul_f32 v64, v254, v64
    v_mul_f32 v65, v254, v65
    v_mul_f32 v66, v254, v66
    v_mul_f32 v67, v254, v67
    v_mul_f32 v76, v254, v76
    v_mul_f32 v77, v254, v77
    v_mul_f32 v78, v254, v78
    v_mul_f32 v79, v254, v79
    v_mul_f32 v88, v254, v88
    v_mul_f32 v89, v254, v89
    v_mul_f32 v90, v254, v90
    v_mul_f32 v91, v254, v91
    v_max3_f32 v252, v180, v181, v182
    v_max3_f32 v252, v252, v183, v192
    v_max3_f32 v252, v252, v193, v194
    v_max_f32 v252, v252, v195
    v_mov_b32 v253, v252
    s_nop 1
    v_permlane32_swap_b32 v252, v253
    v_max_f32 v252, v252, v253
    v_mov_b32 v253, v252
    s_nop 1
    v_permlane16_swap_b32 v252, v253
    v_max_f32 v252, v252, v253
    v_max_f32 v252, 0, v252
    v_exp_f32 v254, -v252
    v_sub_f32 v180, v180, v252
    v_sub_f32 v181, v181, v252
    v_sub_f32 v182, v182, v252
    v_sub_f32 v183, v183, v252
    v_sub_f32 v192, v192, v252
    v_sub_f32 v193, v193, v252
    v_sub_f32 v194, v194, v252
    v_sub_f32 v195, v195, v252
    v_sub_f32 v164, v164, v252
    v_sub_f32 v165, v165, v252
    v_sub_f32 v166, v166, v252
    v_sub_f32 v167, v167, v252
    v_mul_f32 v104, v254, v104
    v_mul_f32 v105, v254, v105
    v_mul_f32 v106, v254, v106
    v_mul_f32 v107, v254, v107
    v_mul_f32 v8, v254, v8
    v_mul_f32 v9, v254, v9
    v_mul_f32 v10, v254, v10
    v_mul_f32 v11, v254, v11
    v_mul_f32 v20, v254, v20
    v_mul_f32 v21, v254, v21
    v_mul_f32 v22, v254, v22
    v_mul_f32 v23, v254, v23
    v_mul_f32 v32, v254, v32
    v_mul_f32 v33, v254, v33
    v_mul_f32 v34, v254, v34
    v_mul_f32 v35, v254, v35
    v_mul_f32 v44, v254, v44
    v_mul_f32 v45, v254, v45
    v_mul_f32 v46, v254, v46
    v_mul_f32 v47, v254, v47
    v_mul_f32 v56, v254, v56
    v_mul_f32 v57, v254, v57
    v_mul_f32 v58, v254, v58
    v_mul_f32 v59, v254, v59
    v_mul_f32 v68, v254, v68
    v_mul_f32 v69, v254, v69
    v_mul_f32 v70, v254, v70
    v_mul_f32 v71, v254, v71
    v_mul_f32 v80, v254, v80
    v_mul_f32 v81, v254, v81
    v_mul_f32 v82, v254, v82
    v_mul_f32 v83, v254, v83
    v_mul_f32 v92, v254, v92
    v_mul_f32 v93, v254, v93
    v_mul_f32 v94, v254, v94
    v_mul_f32 v95, v254, v95
    s_nop 1
    s_branch K1_BACK5
K1_RARE6:
    s_nop 7
    v_max3_f32 v252, v172, v173, v174
    v_max3_f32 v252, v252, v175, v184
    v_max3_f32 v252, v252, v185, v186
    v_max_f32 v252, v252, v187
    v_mov_b32 v253, v252
    s_nop 1
    v_permlane32_swap_b32 v252, v253
    v_max_f32 v252, v252, v253
    v_mov_b32 v253, v252
    s_nop 1
    v_permlane16_swap_b32 v252, v253
    v_max_f32 v252, v252, v253
    v_max_f32 v252, 0, v252
    v_exp_f32 v254, -v252
    v_sub_f32 v172, v172, v252
    v_sub_f32 v173, v173, v252
    v_sub_f32 v174, v174, v252
    v_sub_f32 v175, v175, v252
    v_sub_f32 v184, v184, v252
    v_sub_f32 v185, v185, v252
    v_sub_f32 v186, v186, v252
    v_sub_f32 v187, v187, v252
    v_sub_f32 v156, v156, v252
    v_sub_f32 v157, v157, v252
    v_sub_f32 v158, v158, v252
    v_sub_f32 v159, v159, v252
    v_mul_f32 v96, v254, v96
    v_mul_f32 v97, v254, v97
    v_mul_f32 v98, v254, v98
    v_mul_f32 v99, v254, v99
    v_mul_f32 v0, v254, v0
    v_mul_f32 v1, v254, v1
    v_mul_f32 v2, v254, v2
    v_mul_f32 v3, v254, v3
    v_mul_f32 v12, v254, v12
    v_mul_f32 v13, v254, v13
    v_mul_f32 v14, v254, v14
    v_mul_f32 v15, v254, v15
    v_mul_f32 v24, v254, v24
    v_mul_f32 v25, v254, v25
    v_mul_f32 v26, v254, v26
    v_mul_f32 v27, v254, v27
    v_mul_f32 v36, v254, v36
    v_mul_f32 v37, v254, v37
    v_mul_f32 v38, v254, v38
    v_mul_f32 v39, v254, v39
    v_mul_f32 v48, v254, v48
    v_mul_f32 v49, v254, v49
    v_mul_f32 v50, v254, v50
    v_mul_f32 v51, v254, v51
    v_mul_f32 v60, v254, v60
    v_mul_f32 v61, v254, v61
    v_mul_f32 v62, v254, v62
    v_mul_f32 v63, v254, v63
    v_mul_f32 v72, v254, v72
    v_mul_f32 v73, v254, v73
    v_mul_f32 v74, v254, v74
    v_mul_f32 v75, v254, v75
    v_mul_f32 v84, v254, v84
    v_mul_f32 v85, v254, v85
    v_mul_f32 v86, v254, v86
    v_mul_f32 v87, v254, v87
    v_max3_f32 v252, v176, v177, v178
    v_max3_f32 v252, v252, v179, v188
    v_max3_f32 v252, v252, v189, v190
    v_max_f32 v252, v252, v191
    v_mov_b32 v253, v252
    s_nop 1
    v_permlane32_swap_b32 v252, v253
    v_max_f32 v252, v252, v253
    v_mov_b32 v253, v252
    s_nop 1
    v_permlane16_swap_b32 v252, v253
    v_max_f32 v252, v252, v253
    v_max_f32 v252, 0, v252
    v_exp_f32 v254, -v252
    v_sub_f32 v176, v176, v252
    v_sub_f32 v177, v177, v252
    v_sub_f32 v178, v178, v252
    v_sub_f32 v179, v179, v252
    v_sub_f32 v188, v188, v252
    v_sub_f32 v189, v189, v252
    v_sub_f32 v190, v190, v252
    v_sub_f32 v191, v191, v252
    v_sub_f32 v160, v160, v252
    v_sub_f32 v161, v161, v252
    v_sub_f32 v162, v162, v252
    v_sub_f32 v163, v163, v252
    v_mul_f32 v100, v254, v100
    v_mul_f32 v101, v254, v101
    v_mul_f32 v102, v254, v102
    v_mul_f32 v103, v254, v103
    v_mul_f32 v4, v254, v4
    v_mul_f32 v5, v254, v5
    v_mul_f32 v6, v254, v6
    v_mul_f32 v7, v254, v7
    v_mul_f32 v16, v254, v16
    v_mul_f32 v17, v254, v17
    v_mul_f32 v18, v254, v18
    v_mul_f32 v19, v254, v19
    v_mul_f32 v28, v254, v28
    v_mul_f32 v29, v254, v29
    v_mul_f32 v30, v254, v30
    v_mul_f32 v31, v254, v31
    v_mul_f32 v40, v254, v40
    v_mul_f32 v41, v254, v41
    v_mul_f32 v42, v254, v42
    v_mul_f32 v43, v254, v43
    v_mul_f32 v52, v254, v52
    v_mul_f32 v53, v254, v53
    v_mul_f32 v54, v254, v54
    v_mul_f32 v55, v254, v55
    v_mul_f32 v64, v254, v64
    v_mul_f32 v65, v254, v65
    v_mul_f32 v66, v254, v66
    v_mul_f32 v67, v254, v67
    v_mul_f32 v76, v254, v76
    v_mul_f32 v77, v254, v77
    v_mul_f32 v78, v254, v78
    v_mul_f32 v79, v254, v79
    v_mul_f32 v88, v254, v88
    v_mul_f32 v89, v254, v89
    v_mul_f32 v90, v254, v90
    v_mul_f32 v91, v254, v91
    v_max3_f32 v252, v180, v181, v182
    v_max3_f32 v252, v252, v183, v192
    v_max3_f32 v252, v252, v193, v194
    v_max_f32 v252, v252, v195
    v_mov_b32 v253, v252
    s_nop 1
    v_permlane32_swap_b32 v252, v253
    v_max_f32 v252, v252, v253
    v_mov_b32 v253, v252
    s_nop 1
    v_permlane16_swap_b32 v252, v253
    v_max_f32 v252, v252, v253
    v_max_f32 v252, 0, v252
    v_exp_f32 v254, -v252
    v_sub_f32 v180, v180, v252
    v_sub_f32 v181, v181, v252
    v_sub_f32 v182, v182, v252
    v_sub_f32 v183, v183, v252
    v_sub_f32 v192, v192, v252
    v_sub_f32 v193, v193, v252
    v_sub_f32 v194, v194, v252
    v_sub_f32 v195, v195, v252
    v_sub_f32 v164, v164, v252
    v_sub_f32 v165, v165, v252
    v_sub_f32 v166, v166, v252
    v_sub_f32 v167, v167, v252
    v_mul_f32 v104, v254, v104
    v_mul_f32 v105, v254, v105
    v_mul_f32 v106, v254, v106
    v_mul_f32 v107, v254, v107
    v_mul_f32 v8, v254, v8
    v_mul_f32 v9, v254, v9
    v_mul_f32 v10, v254, v10
    v_mul_f32 v11, v254, v11
    v_mul_f32 v20, v254, v20
    v_mul_f32 v21, v254, v21
    v_mul_f32 v22, v254, v22
    v_mul_f32 v23, v254, v23
    v_mul_f32 v32, v254, v32
    v_mul_f32 v33, v254, v33
    v_mul_f32 v34, v254, v34
    v_mul_f32 v35, v254, v35
    v_mul_f32 v44, v254, v44
    v_mul_f32 v45, v254, v45
    v_mul_f32 v46, v254, v46
    v_mul_f32 v47, v254, v47
    v_mul_f32 v56, v254, v56
    v_mul_f32 v57, v254, v57
    v_mul_f32 v58, v254, v58
    v_mul_f32 v59, v254, v59
    v_mul_f32 v68, v254, v68
    v_mul_f32 v69, v254, v69
    v_mul_f32 v70, v254, v70
    v_mul_f32 v71, v254, v71
    v_mul_f32 v80, v254, v80
    v_mul_f32 v81, v254, v81
    v_mul_f32 v82, v254, v82
    v_mul_f32 v83, v254, v83
    v_mul_f32 v92, v254, v92
    v_mul_f32 v93, v254, v93
    v_mul_f32 v94, v254, v94
    v_mul_f32 v95, v254, v95
    s_nop 1
    s_branch K1_BACK6
K1_RARE7:
    s_nop 7
    v_max3_f32 v252, v172, v173, v174
    v_max3_f32 v252, v252, v175, v184
    v_max3_f32 v252, v252, v185, v186
    v_max_f32 v252, v252, v187
    v_mov_b32 v253, v252
    s_nop 1
    v_permlane32_swap_b32 v252, v253
    v_max_f32 v252, v252, v253
    v_mov_b32 v253, v252
    s_nop 1
    v_permlane16_swap_b32 v252, v253
    v_max_f32 v252, v252, v253
    v_max_f32 v252, 0, v252
    v_exp_f32 v254, -v252
    v_sub_f32 v172, v172, v252
    v_sub_f32 v173, v173, v252
    v_sub_f32 v174, v174, v252
    v_sub_f32 v175, v175, v252
    v_sub_f32 v184, v184, v252
    v_sub_f32 v185, v185, v252
    v_sub_f32 v186, v186, v252
    v_sub_f32 v187, v187, v252
    v_sub_f32 v156, v156, v252
    v_sub_f32 v157, v157, v252
    v_sub_f32 v158, v158, v252
    v_sub_f32 v159, v159, v252
    v_mul_f32 v96, v254, v96
    v_mul_f32 v97, v254, v97
    v_mul_f32 v98, v254, v98
    v_mul_f32 v99, v254, v99
    v_mul_f32 v0, v254, v0
    v_mul_f32 v1, v254, v1
    v_mul_f32 v2, v254, v2
    v_mul_f32 v3, v254, v3
    v_mul_f32 v12, v254, v12
    v_mul_f32 v13, v254, v13
    v_mul_f32 v14, v254, v14
    v_mul_f32 v15, v254, v15
    v_mul_f32 v24, v254, v24
    v_mul_f32 v25, v254, v25
    v_mul_f32 v26, v254, v26
    v_mul_f32 v27, v254, v27
    v_mul_f32 v36, v254, v36
    v_mul_f32 v37, v254, v37
    v_mul_f32 v38, v254, v38
    v_mul_f32 v39, v254, v39
    v_mul_f32 v48, v254, v48
    v_mul_f32 v49, v254, v49
    v_mul_f32 v50, v254, v50
    v_mul_f32 v51, v254, v51
    v_mul_f32 v60, v254, v60
    v_mul_f32 v61, v254, v61
    v_mul_f32 v62, v254, v62
    v_mul_f32 v63, v254, v63
    v_mul_f32 v72, v254, v72
    v_mul_f32 v73, v254, v73
    v_mul_f32 v74, v254, v74
    v_mul_f32 v75, v254, v75
    v_mul_f32 v84, v254, v84
    v_mul_f32 v85, v254, v85
    v_mul_f32 v86, v254, v86
    v_mul_f32 v87, v254, v87
    v_max3_f32 v252, v176, v177, v178
    v_max3_f32 v252, v252, v179, v188
    v_max3_f32 v252, v252, v189, v190
    v_max_f32 v252, v252, v191
    v_mov_b32 v253, v252
    s_nop 1
    v_permlane32_swap_b32 v252, v253
    v_max_f32 v252, v252, v253
    v_mov_b32 v253, v252
    s_nop 1
    v_permlane16_swap_b32 v252, v253
    v_max_f32 v252, v252, v253
    v_max_f32 v252, 0, v252
    v_exp_f32 v254, -v252
    v_sub_f32 v176, v176, v252
    v_sub_f32 v177, v177, v252
    v_sub_f32 v178, v178, v252
    v_sub_f32 v179, v179, v252
    v_sub_f32 v188, v188, v252
    v_sub_f32 v189, v189, v252
    v_sub_f32 v190, v190, v252
    v_sub_f32 v191, v191, v252
    v_sub_f32 v160, v160, v252
    v_sub_f32 v161, v161, v252
    v_sub_f32 v162, v162, v252
    v_sub_f32 v163, v163, v252
    v_mul_f32 v100, v254, v100
    v_mul_f32 v101, v254, v101
    v_mul_f32 v102, v254, v102
    v_mul_f32 v103, v254, v103
    v_mul_f32 v4, v254, v4
    v_mul_f32 v5, v254, v5
    v_mul_f32 v6, v254, v6
    v_mul_f32 v7, v254, v7
    v_mul_f32 v16, v254, v16
    v_mul_f32 v17, v254, v17
    v_mul_f32 v18, v254, v18
    v_mul_f32 v19, v254, v19
    v_mul_f32 v28, v254, v28
    v_mul_f32 v29, v254, v29
    v_mul_f32 v30, v254, v30
    v_mul_f32 v31, v254, v31
    v_mul_f32 v40, v254, v40
    v_mul_f32 v41, v254, v41
    v_mul_f32 v42, v254, v42
    v_mul_f32 v43, v254, v43
    v_mul_f32 v52, v254, v52
    v_mul_f32 v53, v254, v53
    v_mul_f32 v54, v254, v54
    v_mul_f32 v55, v254, v55
    v_mul_f32 v64, v254, v64
    v_mul_f32 v65, v254, v65
    v_mul_f32 v66, v254, v66
    v_mul_f32 v67, v254, v67
    v_mul_f32 v76, v254, v76
    v_mul_f32 v77, v254, v77
    v_mul_f32 v78, v254, v78
    v_mul_f32 v79, v254, v79
    v_mul_f32 v88, v254, v88
    v_mul_f32 v89, v254, v89
    v_mul_f32 v90, v254, v90
    v_mul_f32 v91, v254, v91
    v_max3_f32 v252, v180, v181, v182
    v_max3_f32 v252, v252, v183, v192
    v_max3_f32 v252, v252, v193, v194
    v_max_f32 v252, v252, v195
    v_mov_b32 v253, v252
    s_nop 1
    v_permlane32_swap_b32 v252, v253
    v_max_f32 v252, v252, v253
    v_mov_b32 v253, v252
    s_nop 1
    v_permlane16_swap_b32 v252, v253
    v_max_f32 v252, v252, v253
    v_max_f32 v252, 0, v252
    v_exp_f32 v254, -v252
    v_sub_f32 v180, v180, v252
    v_sub_f32 v181, v181, v252
    v_sub_f32 v182, v182, v252
    v_sub_f32 v183, v183, v252
    v_sub_f32 v192, v192, v252
    v_sub_f32 v193, v193, v252
    v_sub_f32 v194, v194, v252
    v_sub_f32 v195, v195, v252
    v_sub_f32 v164, v164, v252
    v_sub_f32 v165, v165, v252
    v_sub_f32 v166, v166, v252
    v_sub_f32 v167, v167, v252
    v_mul_f32 v104, v254, v104
    v_mul_f32 v105, v254, v105
    v_mul_f32 v106, v254, v106
    v_mul_f32 v107, v254, v107
    v_mul_f32 v8, v254, v8
    v_mul_f32 v9, v254, v9
    v_mul_f32 v10, v254, v10
    v_mul_f32 v11, v254, v11
    v_mul_f32 v20, v254, v20
    v_mul_f32 v21, v254, v21
    v_mul_f32 v22, v254, v22
    v_mul_f32 v23, v254, v23
    v_mul_f32 v32, v254, v32
    v_mul_f32 v33, v254, v33
    v_mul_f32 v34, v254, v34
    v_mul_f32 v35, v254, v35
    v_mul_f32 v44, v254, v44
    v_mul_f32 v45, v254, v45
    v_mul_f32 v46, v254, v46
    v_mul_f32 v47, v254, v47
    v_mul_f32 v56, v254, v56
    v_mul_f32 v57, v254, v57
    v_mul_f32 v58, v254, v58
    v_mul_f32 v59, v254, v59
    v_mul_f32 v68, v254, v68
    v_mul_f32 v69, v254, v69
    v_mul_f32 v70, v254, v70
    v_mul_f32 v71, v254, v71
    v_mul_f32 v80, v254, v80
    v_mul_f32 v81, v254, v81
    v_mul_f32 v82, v254, v82
    v_mul_f32 v83, v254, v83
    v_mul_f32 v92, v254, v92
    v_mul_f32 v93, v254, v93
    v_mul_f32 v94, v254, v94
    v_mul_f32 v95, v254, v95
    s_nop 1
    s_branch K1_BACK7
.globl gqa_oproj_kernel
.p2align 8
.type gqa_oproj_kernel,@function
gqa_oproj_kernel:
    s_cmp_ge_u32 s2, 256
    s_cbranch_scc1 K2_END
    s_load_dwordx2 s[26:27], s[0:1], 40
    s_load_dwordx2 s[28:29], s[0:1], 56
    v_lshrrev_b32 v1, 6, v0
    v_and_b32 v2, 63, v0
    v_readfirstlane_b32 s34, v1
    s_and_b32 s35, s2, 7
    s_lshr_b32 s36, s2, 3
    s_and_b32 s38, s35, 1
    s_lshl_b32 s38, s38, 2
    s_lshr_b32 s39, s36, 3
    s_add_u32 s38, s38, s39
    s_lshr_b32 s37, s35, 1
    s_lshl_b32 s37, s37, 3
    s_and_b32 s39, s36, 7
    s_add_u32 s39, s39, s37
    v_lshlrev_b32 v24, 4, v2
    s_lshl_b32 s45, s39, 3
    s_add_u32 s45, s45, s34
    s_lshl_b32 s45, s45, 15
    s_add_u32 s45, s45, 4194304
    s_lshl_b32 s44, s38, 3
    s_add_u32 s44, s44, s34
    s_mul_i32 s44, s44, 49152
    s_waitcnt lgkmcnt(0)
    s_add_u32 s8, s28, s45
    s_addc_u32 s9, s29, 0
    s_mov_b32 s10, 32768
    s_mov_b32 s11, 0x20000
    s_add_u32 s4, s28, s44
    s_addc_u32 s5, s29, 0
    s_mov_b32 s6, 49152
    s_mov_b32 s7, 0x20000
    s_lshl_b32 s60, s39, 1
    s_lshl_b32 s61, s38, 2
    s_add_u32 s60, s60, s61
    s_mov_b32 s47, 0
    s_mov_b32 s48, 0
    buffer_load_dwordx4 v[32:35], v24, s[8:11], s47 offen offset:0
    buffer_load_dwordx4 v[36:39], v24, s[8:11], s47 offen offset:1024
    buffer_load_dwordx4 v[40:43], v24, s[4:7], s48 offen offset:0
    buffer_load_dwordx4 v[44:47], v24, s[4:7], s48 offen offset:1024
    buffer_load_dwordx4 v[48:51], v24, s[4:7], s48 offen offset:2048
    s_mov_b32 s47, 2048
    s_mov_b32 s48, 3072
    buffer_load_dwordx4 v[52:55], v24, s[8:11], s47 offen offset:0
    buffer_load_dwordx4 v[56:59], v24, s[8:11], s47 offen offset:1024
    buffer_load_dwordx4 v[60:63], v24, s[4:7], s48 offen offset:0
    buffer_load_dwordx4 v[64:67], v24, s[4:7], s48 offen offset:1024
    buffer_load_dwordx4 v[68:71], v24, s[4:7], s48 offen offset:2048
    s_mov_b32 s47, 4096
    s_mov_b32 s48, 6144
    buffer_load_dwordx4 v[72:75], v24, s[8:11], s47 offen offset:0
    buffer_load_dwordx4 v[76:79], v24, s[8:11], s47 offen offset:1024
    buffer_load_dwordx4 v[80:83], v24, s[4:7], s48 offen offset:0
    buffer_load_dwordx4 v[84:87], v24, s[4:7], s48 offen offset:1024
    buffer_load_dwordx4 v[88:91], v24, s[4:7], s48 offen offset:2048
    s_mov_b32 s47, 6144
    s_mov_b32 s48, 9216
    buffer_load_dwordx4 v[92:95], v24, s[8:11], s47 offen offset:0
    buffer_load_dwordx4 v[96:99], v24, s[8:11], s47 offen offset:1024
    buffer_load_dwordx4 v[100:103], v24, s[4:7], s48 offen offset:0
    buffer_load_dwordx4 v[104:107], v24, s[4:7], s48 offen offset:1024
    buffer_load_dwordx4 v[108:111], v24, s[4:7], s48 offen offset:2048
    s_mov_b32 s47, 8192
    s_mov_b32 s48, 12288
    buffer_load_dwordx4 v[112:115], v24, s[8:11], s47 offen offset:0
    buffer_load_dwordx4 v[116:119], v24, s[8:11], s47 offen offset:1024
    buffer_load_dwordx4 v[120:123], v24, s[4:7], s48 offen offset:0
    buffer_load_dwordx4 v[124:127], v24, s[4:7], s48 offen offset:1024
    buffer_load_dwordx4 v[128:131], v24, s[4:7], s48 offen offset:2048
    s_mov_b32 s47, 10240
    s_mov_b32 s48, 15360
    buffer_load_dwordx4 v[132:135], v24, s[8:11], s47 offen offset:0
    buffer_load_dwordx4 v[136:139], v24, s[8:11], s47 offen offset:1024
    buffer_load_dwordx4 v[140:143], v24, s[4:7], s48 offen offset:0
    buffer_load_dwordx4 v[144:147], v24, s[4:7], s48 offen offset:1024
    buffer_load_dwordx4 v[148:151], v24, s[4:7], s48 offen offset:2048
    s_mov_b32 s47, 12288
    s_mov_b32 s48, 18432
    buffer_load_dwordx4 v[152:155], v24, s[8:11], s47 offen offset:0
    buffer_load_dwordx4 v[156:159], v24, s[8:11], s47 offen offset:1024
    buffer_load_dwordx4 v[160:163], v24, s[4:7], s48 offen offset:0
    buffer_load_dwordx4 v[164:167], v24, s[4:7], s48 offen offset:1024
    buffer_load_dwordx4 v[168:171], v24, s[4:7], s48 offen offset:2048
    s_mov_b32 s47, 14336
    s_mov_b32 s48, 21504
    buffer_load_dwordx4 v[172:175], v24, s[8:11], s47 offen offset:0
    buffer_load_dwordx4 v[176:179], v24, s[8:11], s47 offen offset:1024
    buffer_load_dwordx4 v[180:183], v24, s[4:7], s48 offen offset:0
    buffer_load_dwordx4 v[184:187], v24, s[4:7], s48 offen offset:1024
    buffer_load_dwordx4 v[188:191], v24, s[4:7], s48 offen offset:2048
    s_mov_b32 s47, 16384
    s_mov_b32 s48, 24576
    buffer_load_dwordx4 v[192:195], v24, s[8:11], s47 offen offset:0
    buffer_load_dwordx4 v[196:199], v24, s[8:11], s47 offen offset:1024
    buffer_load_dwordx4 v[200:203], v24, s[4:7], s48 offen offset:0
    buffer_load_dwordx4 v[204:207], v24, s[4:7], s48 offen offset:1024
    buffer_load_dwordx4 v[208:211], v24, s[4:7], s48 offen offset:2048
    s_mov_b32 s47, 18432
    s_mov_b32 s48, 27648
    buffer_load_dwordx4 v[212:215], v24, s[8:11], s47 offen offset:0
    buffer_load_dwordx4 v[216:219], v24, s[8:11], s47 offen offset:1024
    buffer_load_dwordx4 v[220:223], v24, s[4:7], s48 offen offset:0
    buffer_load_dwordx4 v[224:227], v24, s[4:7], s48 offen offset:1024
    buffer_load_dwordx4 v[228:231], v24, s[4:7], s48 offen offset:2048
    s_mov_b32 s47, 20480
    s_mov_b32 s48, 30720
    buffer_load_dwordx4 v[232:235], v24, s[8:11], s47 offen offset:0
    buffer_load_dwordx4 v[236:239], v24, s[8:11], s47 offen offset:1024
    buffer_load_dwordx4 v[240:243], v24, s[4:7], s48 offen offset:0
    buffer_load_dwordx4 v[244:247], v24, s[4:7], s48 offen offset:1024
    buffer_load_dwordx4 v[248:251], v24, s[4:7], s48 offen offset:2048
    s_mov_b32 s12, s26
    s_mov_b32 s13, s27
    s_mov_b32 s14, 786432
    s_mov_b32 s15, 0x20000
    v_lshrrev_b32 v3, 4, v2
    v_and_b32 v4, 15, v2
    s_cmp_ge_u32 s34, 3
    s_cselect_b32 s50, 1, 0
    s_mul_i32 s51, s50, 3
    s_sub_u32 s51, s34, s51
    s_mul_i32 s52, s38, 48
    s_lshl_b32 s53, s51, 4
    s_add_u32 s52, s52, s53
    s_lshl_b32 s52, s52, 11
    s_lshl_b32 s53, s50, 5
    s_add_u32 s52, s52, s53
    s_lshl_b32 s46, s39, 6
    s_add_u32 s52, s52, s46
    v_lshlrev_b32 v25, 11, v4
    v_lshl_add_u32 v25, v3, 3, v25
    v_add_u32 v25, s52, v25
    s_mul_i32 s42, s34, 6144
    v_add_u32 v26, s42, v24
    s_lshl_b32 s53, s34, 10
    v_add_u32 v27, s53, v24
    s_waitcnt vmcnt(52)
    v_mfma_f32_16x16x32_bf16 v[0:3], v[32:35], v[40:43], 0
    v_mfma_f32_16x16x32_bf16 v[12:15], v[36:39], v[40:43], 0
    s_waitcnt vmcnt(51)
    v_mfma_f32_16x16x32_bf16 v[4:7], v[32:35], v[44:47], 0
    v_mfma_f32_16x16x32_bf16 v[16:19], v[36:39], v[44:47], 0
    s_waitcnt vmcnt(50)
    v_mfma_f32_16x16x32_bf16 v[8:11], v[32:35], v[48:51], 0
    v_mfma_f32_16x16x32_bf16 v[20:23], v[36:39], v[48:51], 0
    s_mov_b32 s47, 22528
    s_mov_b32 s48, 33792
    buffer_load_dwordx4 v[32:35], v24, s[8:11], s47 offen offset:0
    buffer_load_dwordx4 v[36:39], v24, s[8:11], s47 offen offset:1024
    buffer_load_dwordx4 v[40:43], v24, s[4:7], s48 offen offset:0
    buffer_load_dwordx4 v[44:47], v24, s[4:7], s48 offen offset:1024
    buffer_load_dwordx4 v[48:51], v24, s[4:7], s48 offen offset:2048
    s_waitcnt vmcnt(52)
    v_mfma_f32_16x16x32_bf16 v[0:3], v[52:55], v[60:63], v[0:3]
    v_mfma_f32_16x16x32_bf16 v[12:15], v[56:59], v[60:63], v[12:15]
    s_waitcnt vmcnt(51)
    v_mfma_f32_16x16x32_bf16 v[4:7], v[52:55], v[64:67], v[4:7]
    v_mfma_f32_16x16x32_bf16 v[16:19], v[56:59], v[64:67], v[16:19]
    s_waitcnt vmcnt(50)
    v_mfma_f32_16x16x32_bf16 v[8:11], v[52:55], v[68:71], v[8:11]
    v_mfma_f32_16x16x32_bf16 v[20:23], v[56:59], v[68:71], v[20:23]
    s_mov_b32 s47, 24576
    s_mov_b32 s48, 36864
    buffer_load_dwordx4 v[52:55], v24, s[8:11], s47 offen offset:0
    buffer_load_dwordx4 v[56:59], v24, s[8:11], s47 offen offset:1024
    buffer_load_dwordx4 v[60:63], v24, s[4:7], s48 offen offset:0
    buffer_load_dwordx4 v[64:67], v24, s[4:7], s48 offen offset:1024
    buffer_load_dwordx4 v[68:71], v24, s[4:7], s48 offen offset:2048
    s_waitcnt vmcnt(52)
    v_mfma_f32_16x16x32_bf16 v[0:3], v[72:75], v[80:83], v[0:3]
    v_mfma_f32_16x16x32_bf16 v[12:15], v[76:79], v[80:83], v[12:15]
    s_waitcnt vmcnt(51)
    v_mfma_f32_16x16x32_bf16 v[4:7], v[72:75], v[84:87], v[4:7]
    v_mfma_f32_16x16x32_bf16 v[16:19], v[76:79], v[84:87], v[16:19]
    s_waitcnt vmcnt(50)
    v_mfma_f32_16x16x32_bf16 v[8:11], v[72:75], v[88:91], v[8:11]
    v_mfma_f32_16x16x32_bf16 v[20:23], v[76:79], v[88:91], v[20:23]
    s_mov_b32 s47, 26624
    s_mov_b32 s48, 39936
    buffer_load_dwordx4 v[72:75], v24, s[8:11], s47 offen offset:0
    buffer_load_dwordx4 v[76:79], v24, s[8:11], s47 offen offset:1024
    buffer_load_dwordx4 v[80:83], v24, s[4:7], s48 offen offset:0
    buffer_load_dwordx4 v[84:87], v24, s[4:7], s48 offen offset:1024
    buffer_load_dwordx4 v[88:91], v24, s[4:7], s48 offen offset:2048
    s_waitcnt vmcnt(52)
    v_mfma_f32_16x16x32_bf16 v[0:3], v[92:95], v[100:103], v[0:3]
    v_mfma_f32_16x16x32_bf16 v[12:15], v[96:99], v[100:103], v[12:15]
    s_waitcnt vmcnt(51)
    v_mfma_f32_16x16x32_bf16 v[4:7], v[92:95], v[104:107], v[4:7]
    v_mfma_f32_16x16x32_bf16 v[16:19], v[96:99], v[104:107], v[16:19]
    s_waitcnt vmcnt(50)
    v_mfma_f32_16x16x32_bf16 v[8:11], v[92:95], v[108:111], v[8:11]
    v_mfma_f32_16x16x32_bf16 v[20:23], v[96:99], v[108:111], v[20:23]
    s_mov_b32 s47, 28672
    s_mov_b32 s48, 43008
    buffer_load_dwordx4 v[92:95], v24, s[8:11], s47 offen offset:0
    buffer_load_dwordx4 v[96:99], v24, s[8:11], s47 offen offset:1024
    buffer_load_dwordx4 v[100:103], v24, s[4:7], s48 offen offset:0
    buffer_load_dwordx4 v[104:107], v24, s[4:7], s48 offen offset:1024
    buffer_load_dwordx4 v[108:111], v24, s[4:7], s48 offen offset:2048
    s_waitcnt vmcnt(52)
    v_mfma_f32_16x16x32_bf16 v[0:3], v[112:115], v[120:123], v[0:3]
    v_mfma_f32_16x16x32_bf16 v[12:15], v[116:119], v[120:123], v[12:15]
    s_waitcnt vmcnt(51)
    v_mfma_f32_16x16x32_bf16 v[4:7], v[112:115], v[124:127], v[4:7]
    v_mfma_f32_16x16x32_bf16 v[16:19], v[116:119], v[124:127], v[16:19]
    s_waitcnt vmcnt(50)
    v_mfma_f32_16x16x32_bf16 v[8:11], v[112:115], v[128:131], v[8:11]
    v_mfma_f32_16x16x32_bf16 v[20:23], v[116:119], v[128:131], v[20:23]
    s_mov_b32 s47, 30720
    s_mov_b32 s48, 46080
    buffer_load_dwordx4 v[112:115], v24, s[8:11], s47 offen offset:0
    buffer_load_dwordx4 v[116:119], v24, s[8:11], s47 offen offset:1024
    buffer_load_dwordx4 v[120:123], v24, s[4:7], s48 offen offset:0
    buffer_load_dwordx4 v[124:127], v24, s[4:7], s48 offen offset:1024
    buffer_load_dwordx4 v[128:131], v24, s[4:7], s48 offen offset:2048
    s_waitcnt vmcnt(52)
    v_mfma_f32_16x16x32_bf16 v[0:3], v[132:135], v[140:143], v[0:3]
    v_mfma_f32_16x16x32_bf16 v[12:15], v[136:139], v[140:143], v[12:15]
    s_waitcnt vmcnt(51)
    v_mfma_f32_16x16x32_bf16 v[4:7], v[132:135], v[144:147], v[4:7]
    v_mfma_f32_16x16x32_bf16 v[16:19], v[136:139], v[144:147], v[16:19]
    s_waitcnt vmcnt(50)
    v_mfma_f32_16x16x32_bf16 v[8:11], v[132:135], v[148:151], v[8:11]
    v_mfma_f32_16x16x32_bf16 v[20:23], v[136:139], v[148:151], v[20:23]
    s_waitcnt vmcnt(47)
    v_mfma_f32_16x16x32_bf16 v[0:3], v[152:155], v[160:163], v[0:3]
    v_mfma_f32_16x16x32_bf16 v[12:15], v[156:159], v[160:163], v[12:15]
    s_waitcnt vmcnt(46)
    v_mfma_f32_16x16x32_bf16 v[4:7], v[152:155], v[164:167], v[4:7]
    v_mfma_f32_16x16x32_bf16 v[16:19], v[156:159], v[164:167], v[16:19]
    s_waitcnt vmcnt(45)
    v_mfma_f32_16x16x32_bf16 v[8:11], v[152:155], v[168:171], v[8:11]
    v_mfma_f32_16x16x32_bf16 v[20:23], v[156:159], v[168:171], v[20:23]
    s_waitcnt vmcnt(42)
    v_mfma_f32_16x16x32_bf16 v[0:3], v[172:175], v[180:183], v[0:3]
    v_mfma_f32_16x16x32_bf16 v[12:15], v[176:179], v[180:183], v[12:15]
    s_waitcnt vmcnt(41)
    v_mfma_f32_16x16x32_bf16 v[4:7], v[172:175], v[184:187], v[4:7]
    v_mfma_f32_16x16x32_bf16 v[16:19], v[176:179], v[184:187], v[16:19]
    s_waitcnt vmcnt(40)
    v_mfma_f32_16x16x32_bf16 v[8:11], v[172:175], v[188:191], v[8:11]
    v_mfma_f32_16x16x32_bf16 v[20:23], v[176:179], v[188:191], v[20:23]
    s_waitcnt vmcnt(37)
    v_mfma_f32_16x16x32_bf16 v[0:3], v[192:195], v[200:203], v[0:3]
    v_mfma_f32_16x16x32_bf16 v[12:15], v[196:199], v[200:203], v[12:15]
    s_waitcnt vmcnt(36)
    v_mfma_f32_16x16x32_bf16 v[4:7], v[192:195], v[204:207], v[4:7]
    v_mfma_f32_16x16x32_bf16 v[16:19], v[196:199], v[204:207], v[16:19]
    s_waitcnt vmcnt(35)
    v_mfma_f32_16x16x32_bf16 v[8:11], v[192:195], v[208:211], v[8:11]
    v_mfma_f32_16x16x32_bf16 v[20:23], v[196:199], v[208:211], v[20:23]
    s_waitcnt vmcnt(32)
    v_mfma_f32_16x16x32_bf16 v[0:3], v[212:215], v[220:223], v[0:3]
    v_mfma_f32_16x16x32_bf16 v[12:15], v[216:219], v[220:223], v[12:15]
    s_waitcnt vmcnt(31)
    v_mfma_f32_16x16x32_bf16 v[4:7], v[212:215], v[224:227], v[4:7]
    v_mfma_f32_16x16x32_bf16 v[16:19], v[216:219], v[224:227], v[16:19]
    s_waitcnt vmcnt(30)
    v_mfma_f32_16x16x32_bf16 v[8:11], v[212:215], v[228:231], v[8:11]
    v_mfma_f32_16x16x32_bf16 v[20:23], v[216:219], v[228:231], v[20:23]
    s_waitcnt vmcnt(27)
    v_mfma_f32_16x16x32_bf16 v[0:3], v[232:235], v[240:243], v[0:3]
    v_mfma_f32_16x16x32_bf16 v[12:15], v[236:239], v[240:243], v[12:15]
    s_waitcnt vmcnt(26)
    v_mfma_f32_16x16x32_bf16 v[4:7], v[232:235], v[244:247], v[4:7]
    v_mfma_f32_16x16x32_bf16 v[16:19], v[236:239], v[244:247], v[16:19]
    s_waitcnt vmcnt(25)
    v_mfma_f32_16x16x32_bf16 v[8:11], v[232:235], v[248:251], v[8:11]
    v_mfma_f32_16x16x32_bf16 v[20:23], v[236:239], v[248:251], v[20:23]
    s_waitcnt vmcnt(22)
    v_mfma_f32_16x16x32_bf16 v[0:3], v[32:35], v[40:43], v[0:3]
    v_mfma_f32_16x16x32_bf16 v[12:15], v[36:39], v[40:43], v[12:15]
    s_waitcnt vmcnt(21)
    v_mfma_f32_16x16x32_bf16 v[4:7], v[32:35], v[44:47], v[4:7]
    v_mfma_f32_16x16x32_bf16 v[16:19], v[36:39], v[44:47], v[16:19]
    s_waitcnt vmcnt(20)
    v_mfma_f32_16x16x32_bf16 v[8:11], v[32:35], v[48:51], v[8:11]
    v_mfma_f32_16x16x32_bf16 v[20:23], v[36:39], v[48:51], v[20:23]
    s_waitcnt vmcnt(17)
    v_mfma_f32_16x16x32_bf16 v[0:3], v[52:55], v[60:63], v[0:3]
    v_mfma_f32_16x16x32_bf16 v[12:15], v[56:59], v[60:63], v[12:15]
    s_waitcnt vmcnt(16)
    v_mfma_f32_16x16x32_bf16 v[4:7], v[52:55], v[64:67], v[4:7]
    v_mfma_f32_16x16x32_bf16 v[16:19], v[56:59], v[64:67], v[16:19]
    s_waitcnt vmcnt(15)
    v_mfma_f32_16x16x32_bf16 v[8:11], v[52:55], v[68:71], v[8:11]
    v_mfma_f32_16x16x32_bf16 v[20:23], v[56:59], v[68:71], v[20:23]
    s_waitcnt vmcnt(12)
    v_mfma_f32_16x16x32_bf16 v[0:3], v[72:75], v[80:83], v[0:3]
    v_mfma_f32_16x16x32_bf16 v[12:15], v[76:79], v[80:83], v[12:15]
    s_waitcnt vmcnt(11)
    v_mfma_f32_16x16x32_bf16 v[4:7], v[72:75], v[84:87], v[4:7]
    v_mfma_f32_16x16x32_bf16 v[16:19], v[76:79], v[84:87], v[16:19]
    s_waitcnt vmcnt(10)
    v_mfma_f32_16x16x32_bf16 v[8:11], v[72:75], v[88:91], v[8:11]
    v_mfma_f32_16x16x32_bf16 v[20:23], v[76:79], v[88:91], v[20:23]
    s_waitcnt vmcnt(7)
    v_mfma_f32_16x16x32_bf16 v[0:3], v[92:95], v[100:103], v[0:3]
    v_mfma_f32_16x16x32_bf16 v[12:15], v[96:99], v[100:103], v[12:15]
    s_waitcnt vmcnt(6)
    v_mfma_f32_16x16x32_bf16 v[4:7], v[92:95], v[104:107], v[4:7]
    v_mfma_f32_16x16x32_bf16 v[16:19], v[96:99], v[104:107], v[16:19]
    s_waitcnt vmcnt(5)
    v_mfma_f32_16x16x32_bf16 v[8:11], v[92:95], v[108:111], v[8:11]
    v_mfma_f32_16x16x32_bf16 v[20:23], v[96:99], v[108:111], v[20:23]
    s_waitcnt vmcnt(2)
    v_mfma_f32_16x16x32_bf16 v[0:3], v[112:115], v[120:123], v[0:3]
    v_mfma_f32_16x16x32_bf16 v[12:15], v[116:119], v[120:123], v[12:15]
    s_waitcnt vmcnt(1)
    v_mfma_f32_16x16x32_bf16 v[4:7], v[112:115], v[124:127], v[4:7]
    v_mfma_f32_16x16x32_bf16 v[16:19], v[116:119], v[124:127], v[16:19]
    s_waitcnt vmcnt(0)
    v_mfma_f32_16x16x32_bf16 v[8:11], v[112:115], v[128:131], v[8:11]
    v_mfma_f32_16x16x32_bf16 v[20:23], v[116:119], v[128:131], v[20:23]
    s_nop 0
    ds_write_b128 v26, v[0:3] offset:0
    s_nop 1
    ds_write_b128 v26, v[4:7] offset:1024
    s_nop 1
    ds_write_b128 v26, v[8:11] offset:2048
    ds_write_b128 v26, v[12:15] offset:3072
    ds_write_b128 v26, v[16:19] offset:4096
    ds_write_b128 v26, v[20:23] offset:5120
    s_waitcnt lgkmcnt(0)
    s_barrier
    s_cmp_ge_u32 s34, 6
    s_cbranch_scc1 K2_END
    ds_read_b128 v[32:35], v27 offset:0
    ds_read_b128 v[36:39], v27 offset:6144
    ds_read_b128 v[40:43], v27 offset:12288
    ds_read_b128 v[44:47], v27 offset:18432
    ds_read_b128 v[48:51], v27 offset:24576
    ds_read_b128 v[52:55], v27 offset:30720
    ds_read_b128 v[56:59], v27 offset:36864
    ds_read_b128 v[60:63], v27 offset:43008
    s_waitcnt lgkmcnt(6)
    v_pk_add_f32 v[32:33], v[32:33], v[36:37]
    v_pk_add_f32 v[34:35], v[34:35], v[38:39]
    s_waitcnt lgkmcnt(5)
    v_pk_add_f32 v[32:33], v[32:33], v[40:41]
    v_pk_add_f32 v[34:35], v[34:35], v[42:43]
    s_waitcnt lgkmcnt(4)
    v_pk_add_f32 v[32:33], v[32:33], v[44:45]
    v_pk_add_f32 v[34:35], v[34:35], v[46:47]
    s_waitcnt lgkmcnt(3)
    v_pk_add_f32 v[32:33], v[32:33], v[48:49]
    v_pk_add_f32 v[34:35], v[34:35], v[50:51]
    s_waitcnt lgkmcnt(2)
    v_pk_add_f32 v[32:33], v[32:33], v[52:53]
    v_pk_add_f32 v[34:35], v[34:35], v[54:55]
    s_waitcnt lgkmcnt(1)
    v_pk_add_f32 v[32:33], v[32:33], v[56:57]
    v_pk_add_f32 v[34:35], v[34:35], v[58:59]
    s_waitcnt lgkmcnt(0)
    v_pk_add_f32 v[32:33], v[32:33], v[60:61]
    v_pk_add_f32 v[34:35], v[34:35], v[62:63]
    v_cvt_pk_bf16_f32 v32, v32, v33
    v_cvt_pk_bf16_f32 v33, v34, v35
    buffer_store_dwordx2 v[32:33], v25, s[12:15], 0 offen
K2_END:
    s_endpgm
.section .rodata,"a"
.p2align 6
.amdhsa_kernel gqa_attn_kernel
  .amdhsa_next_free_vgpr 256
  .amdhsa_next_free_sgpr 96
  .amdhsa_accum_offset 256
  .amdhsa_group_segment_fixed_size 0
  .amdhsa_kernarg_size 64
  .amdhsa_user_sgpr_count 2
  .amdhsa_user_sgpr_kernarg_segment_ptr 1
  .amdhsa_system_sgpr_workgroup_id_x 1
.end_amdhsa_kernel
.p2align 6
.amdhsa_kernel gqa_oproj_kernel
  .amdhsa_next_free_vgpr 256
  .amdhsa_next_free_sgpr 96
  .amdhsa_accum_offset 256
  .amdhsa_group_segment_fixed_size 0
  .amdhsa_kernarg_size 64
  .amdhsa_user_sgpr_count 2
  .amdhsa_user_sgpr_kernarg_segment_ptr 1
  .amdhsa_system_sgpr_workgroup_id_x 1
.end_amdhsa_kernel
```
